```python
import torch

def _softmax(x, axis=-1):
    return torch.softmax(x, dim=axis)
def _gelu(x):
    return torch.nn.functional.gelu(x, approximate="tanh")
def _silu(x):
    return torch.nn.functional.silu(x)
def _sigmoid(x):
    return torch.sigmoid(x)
def _layernorm(x, axis=-1, eps=1e-5):
    m = x.mean(dim=axis, keepdim=True)
    v = x.var(dim=axis, keepdim=True, unbiased=False)
    return (x - m) / torch.sqrt(v + eps)
def _scatter_add(tgt, idx, src, axis=0):
    return tgt.clone().index_add_(axis, idx, src)
def _segment_sum(src, seg, n):
    out = torch.zeros((n,) + src.shape[1:], dtype=src.dtype)
    return out.index_add_(0, seg, src)
def _pad(x, pw):
    flat = tuple(v for pair in reversed(pw) for v in pair)
    return torch.nn.functional.pad(x, flat)

kernel_name = 'sequential_preLN__ssm_conv_s4d__glu_gated_reglu__prompt'

def setup_inputs():

    _w = (lambda a: (lambda t: t.to(torch.bfloat16) if t.is_floating_point() else t)(torch.as_tensor(a)))
    def _A_setup():
        Bsz, L, D, N = 1, 2048, 512, 128
        return {
            "u": _w((lambda *s: torch.randn(*s, dtype=torch.bfloat16) * 0.05)(Bsz, L, D)),
            "log_A_real": _w((lambda *s: torch.randn(*s, dtype=torch.bfloat16) * 6.4)(D, N) * 0.5),
            "A_imag": _w((lambda *s: torch.randn(*s, dtype=torch.bfloat16) * 0.05)(D, N) * 3.14),
            "C_real": _w((lambda *s: torch.randn(*s, dtype=torch.bfloat16) * 0.05)(D, N) / N ** 0.5),
            "C_imag": _w((lambda *s: torch.randn(*s, dtype=torch.bfloat16) * 0.05)(D, N) / N ** 0.5),
            "log_dt": _w((lambda *s: torch.randn(*s, dtype=torch.bfloat16) * 0.05)(D) * 0.5 - 4.0),
            "D_skip": _w((lambda *s: torch.randn(*s, dtype=torch.bfloat16) * 0.05)(D)),
        }
    _A_in = _A_setup()

    def _B_setup():
        B, S, D, F = 1, 2048, 512, 1376
        return {
            "x": _w((lambda *s: torch.randn(*s, dtype=torch.bfloat16) * 0.05)(B, S, D)),
            "W_gate": _w((lambda *s: torch.randn(*s, dtype=torch.bfloat16) * 0.4)(D, F) * (2.0 / D) ** 0.5),
            "W_up": _w((lambda *s: torch.randn(*s, dtype=torch.bfloat16) * 0.4)(D, F) * (2.0 / D) ** 0.5),
            "W_down": _w((lambda *s: torch.randn(*s, dtype=torch.bfloat16) * 0.4)(F, D) * (1.0 / F) ** 0.5),
        }
    _B_in = _B_setup()

    return {
        "A_u": _A_in["u"],
        "A_log_A_real": _A_in["log_A_real"],
        "A_A_imag": _A_in["A_imag"],
        "A_C_real": _A_in["C_real"],
        "A_C_imag": _A_in["C_imag"],
        "A_log_dt": _A_in["log_dt"],
        "A_D_skip": _A_in["D_skip"],
        "B_x": _B_in["x"],
        "B_W_gate": _B_in["W_gate"],
        "B_W_up": _B_in["W_up"],
        "B_W_down": _B_in["W_down"],
    }

def reference(A_u, A_log_A_real, A_A_imag, A_C_real, A_C_imag, A_log_dt, A_D_skip, B_x, B_W_gate, B_W_up, B_W_down):
    def _A_ref(u, log_A_real, A_imag, C_real, C_imag, log_dt, D_skip):
        L = u.shape[1]
        dt = torch.exp(log_dt)
        A = -torch.exp(log_A_real) + 1j * A_imag
        C = (C_real + 1j * C_imag) * dt[:, None]
        pos = (lambda x, dt: x.to(dt))(torch.arange(L), log_dt.dtype)
        P = torch.exp((A * dt[:, None])[:, :, None] * pos[None, None, :])
        K = 2.0 * torch.einsum("dn,dnl->dl", C, P).real
        L2 = 2 * L
        u_t = (lambda x, *d: x.permute(*d))(u, 0, 2, 1)
        Kf = (lambda x, *a, **k: torch.fft.rfft(x.float(), *a, **k))(K, L2)
        Uf = (lambda x, *a, **k: torch.fft.rfft(x.float(), *a, **k))(u_t, L2)
        y = (lambda x, *a, **k: torch.fft.irfft(x, *a, **k).to(torch.bfloat16))(Uf * Kf[None, :, :], L2)[:, :, :L]
        y = (lambda x, *d: x.permute(*d))(y, 0, 2, 1)
        return y + u * D_skip[None, None, :]

    def _B_ref(x, W_gate, W_up, W_down):
        gate = torch.einsum("bsd,df->bsf", x, W_gate)
        up = torch.einsum("bsd,df->bsf", x, W_up)
        gate = gate * (lambda x, dt: x.to(dt))(gate > 0, gate.dtype)
        h = gate * up
        return torch.einsum("bsf,fd->bsd", h, W_down)

    x = A_u
    h = x + _A_ref(_layernorm(x, axis=-1), A_log_A_real, A_A_imag, A_C_real, A_C_imag, A_log_dt, A_D_skip)
    h2 = h + _B_ref(_layernorm(h, axis=-1), B_W_gate, B_W_up, B_W_down)
    return h2
```

```asm
; @launch grid=(256,1,1) block=(512,1,1) lds=163840
.amdgcn_target "amdgcn-amd-amdhsa--gfx950"
.text
.globl sequential_preLN__ssm_conv_s4d__glu_gated_reglu__prompt_kernel
.p2align 8
.type sequential_preLN__ssm_conv_s4d__glu_gated_reglu__prompt_kernel,@function
sequential_preLN__ssm_conv_s4d__glu_gated_reglu__prompt_kernel:
    s_cmp_ge_u32 s2, 256
    s_cbranch_scc1 M_EXIT
    s_load_dwordx16 s[16:31], s[0:1], 0
    s_load_dwordx8 s[32:39], s[0:1], 64
    s_load_dwordx4 s[40:43], s[0:1], 96
    s_getpc_b64 s[66:67]
    s_lshr_b32 s96, s2, 3
    s_lshl_b32 s96, s96, 11
    v_lshlrev_b32 v250, 2, v0
    v_add_u32 v250, s96, v250
    v_min_u32 v250, 0x8a00, v250
    v_and_b32 v1, 63, v0
    v_lshrrev_b32 v2, 6, v0
    v_and_b32 v3, 15, v0
    v_readfirstlane_b32 s44, v2
    v_bfe_u32 v4, v0, 4, 2
    s_and_b32 s50, s2, 7
    s_lshr_b32 s51, s2, 3
    s_and_b32 s49, s50, 1
    s_lshl_b32 s49, s49, 3
    s_and_b32 s52, s51, 7
    s_add_u32 s49, s49, s52
    s_lshr_b32 s52, s50, 1
    s_lshl_b32 s52, s52, 2
    s_lshr_b32 s53, s51, 3
    s_add_u32 s52, s52, s53
    s_lshl_b32 s45, s49, 4
    s_add_u32 s45, s45, s52
    s_lshl_b32 s46, s50, 5
    s_add_u32 s46, s46, s51
    s_lshl_b32 s47, s49, 7
    s_mul_i32 s48, s52, 43
    s_add_u32 s48, s48, 4
    s_lshr_b32 s48, s48, 3
    s_min_u32 s48, s48, 80
    s_lshl_b32 s48, s48, 4
    s_lshr_b32 s72, s52, 3
    s_lshl_b32 s72, s72, 6
    s_add_u32 s72, s72, s47
    s_and_b32 s73, s52, 7
    s_lshl_b32 s73, s73, 6
    s_lshr_b32 s74, s44, 2
    s_mul_i32 s75, s74, 25856
    s_lshl_b32 s76, s46, 1
    s_add_u32 s76, s76, s74
    s_waitcnt lgkmcnt(0)
    s_mov_b32 s8, s42
    s_and_b32 s9, s43, 0xffff
    s_mov_b32 s10, 0xc20000
    s_mov_b32 s11, 0x00020000
    s_mov_b32 s68, s40
    s_and_b32 s69, s41, 0xffff
    s_mov_b32 s70, 0x100
    s_mov_b32 s71, 0x00020000
    s_mov_b32 s4, s16
    s_and_b32 s5, s17, 0xffff
    s_mov_b32 s6, 0x200000
    s_mov_b32 s7, 0x00020000
    v_lshlrev_b32 v5, 4, v1
    s_lshl_b32 s50, s2, 3
    s_add_u32 s50, s50, s44
    s_lshl_b32 s51, s50, 10
    buffer_load_dwordx4 v[8:11], v5, s[4:7], s51 offen
    s_lshl_b32 s52, s76, 8
    v_lshl_add_u32 v7, v1, 2, s52
    s_lshl_b32 s52, s76, 1
    v_mov_b32 v21, s52
    global_load_dword v12, v7, s[18:19]
    global_load_dword v13, v7, s[20:21]
    global_load_dword v14, v7, s[22:23]
    global_load_dword v15, v7, s[24:25]
    global_load_ushort v16, v21, s[26:27]
    global_load_dword v251, v250, s[66:67]
    s_mov_b32 s60, 0xffff0000
    s_waitcnt vmcnt(1)
    v_lshlrev_b32 v24, 16, v8
    v_and_b32 v25, s60, v8
    v_lshlrev_b32 v26, 16, v9
    v_and_b32 v27, s60, v9
    v_lshlrev_b32 v28, 16, v10
    v_and_b32 v29, s60, v10
    v_lshlrev_b32 v30, 16, v11
    v_and_b32 v31, s60, v11
    v_add_f32 v32, v24, v25
    v_add_f32 v33, v26, v27
    v_add_f32 v34, v28, v29
    v_add_f32 v35, v30, v31
    v_add_f32 v32, v32, v33
    v_add_f32 v34, v34, v35
    v_add_f32 v32, v32, v34
    s_nop 1
    v_add_f32_dpp v32, v32, v32 quad_perm:[1,0,3,2] row_mask:0xf bank_mask:0xf
    s_nop 1
    v_add_f32_dpp v32, v32, v32 quad_perm:[2,3,0,1] row_mask:0xf bank_mask:0xf
    s_nop 1
    v_add_f32_dpp v32, v32, v32 row_half_mirror row_mask:0xf bank_mask:0xf
    s_nop 1
    v_add_f32_dpp v32, v32, v32 row_mirror row_mask:0xf bank_mask:0xf
    v_mov_b32 v33, v32
    s_nop 1
    v_permlane16_swap_b32 v32, v33
    v_add_f32 v32, v32, v33
    v_mov_b32 v33, v32
    s_nop 1
    v_permlane32_swap_b32 v32, v33
    v_add_f32 v32, v32, v33
    v_mul_f32 v32, 0x3b000000, v32
    v_sub_f32 v24, v24, v32
    v_sub_f32 v25, v25, v32
    v_sub_f32 v26, v26, v32
    v_sub_f32 v27, v27, v32
    v_sub_f32 v28, v28, v32
    v_sub_f32 v29, v29, v32
    v_sub_f32 v30, v30, v32
    v_sub_f32 v31, v31, v32
    v_mul_f32 v34, v24, v24
    v_mul_f32 v35, v25, v25
    v_fmac_f32 v34, v26, v26
    v_fmac_f32 v35, v27, v27
    v_fmac_f32 v34, v28, v28
    v_fmac_f32 v35, v29, v29
    v_fmac_f32 v34, v30, v30
    v_fmac_f32 v35, v31, v31
    v_add_f32 v34, v34, v35
    s_nop 1
    v_add_f32_dpp v34, v34, v34 quad_perm:[1,0,3,2] row_mask:0xf bank_mask:0xf
    s_nop 1
    v_add_f32_dpp v34, v34, v34 quad_perm:[2,3,0,1] row_mask:0xf bank_mask:0xf
    s_nop 1
    v_add_f32_dpp v34, v34, v34 row_half_mirror row_mask:0xf bank_mask:0xf
    s_nop 1
    v_add_f32_dpp v34, v34, v34 row_mirror row_mask:0xf bank_mask:0xf
    v_mov_b32 v33, v34
    s_nop 1
    v_permlane16_swap_b32 v34, v33
    v_add_f32 v34, v34, v33
    v_mov_b32 v33, v34
    s_nop 1
    v_permlane32_swap_b32 v34, v33
    v_add_f32 v34, v34, v33
    v_mul_f32 v34, 0x3b000000, v34
    v_cvt_pk_bf16_f32 v32, v32, v34
    v_and_b32 v34, s60, v32
    v_lshlrev_b32 v32, 16, v32
    v_add_f32 v34, 0x3727c5ac, v34
    v_cvt_pk_bf16_f32 v34, v34, v34
    v_lshlrev_b32 v34, 16, v34
    v_sqrt_f32 v34, v34
    s_nop 0
    v_cvt_pk_bf16_f32 v34, v34, v34
    v_lshlrev_b32 v34, 16, v34
    v_rcp_f32 v34, v34
    s_mul_i32 s51, s44, 2064
    v_lshl_add_u32 v6, v1, 5, s51
    s_mov_b32 s52, 0x07060302
    s_mov_b32 s53, 0x05040100
    v_lshlrev_b32 v24, 16, v8
    v_and_b32 v25, s60, v8
    v_sub_f32 v24, v24, v32
    v_sub_f32 v25, v25, v32
    v_cvt_pk_bf16_f32 v24, v24, v25
    v_and_b32 v25, s60, v24
    v_lshlrev_b32 v24, 16, v24
    v_mul_f32 v24, v24, v34
    v_mul_f32 v25, v25, v34
    v_cvt_pk_bf16_f32 v24, v24, v25
    v_perm_b32 v36, v8, v24, s53
    v_perm_b32 v37, v8, v24, s52
    v_lshlrev_b32 v24, 16, v9
    v_and_b32 v25, s60, v9
    v_sub_f32 v24, v24, v32
    v_sub_f32 v25, v25, v32
    v_cvt_pk_bf16_f32 v24, v24, v25
    v_and_b32 v25, s60, v24
    v_lshlrev_b32 v24, 16, v24
    v_mul_f32 v24, v24, v34
    v_mul_f32 v25, v25, v34
    v_cvt_pk_bf16_f32 v24, v24, v25
    v_perm_b32 v38, v9, v24, s53
    v_perm_b32 v39, v9, v24, s52
    v_lshlrev_b32 v24, 16, v10
    v_and_b32 v25, s60, v10
    v_sub_f32 v24, v24, v32
    v_sub_f32 v25, v25, v32
    v_cvt_pk_bf16_f32 v24, v24, v25
    v_and_b32 v25, s60, v24
    v_lshlrev_b32 v24, 16, v24
    v_mul_f32 v24, v24, v34
    v_mul_f32 v25, v25, v34
    v_cvt_pk_bf16_f32 v24, v24, v25
    v_perm_b32 v40, v10, v24, s53
    v_perm_b32 v41, v10, v24, s52
    v_lshlrev_b32 v24, 16, v11
    v_and_b32 v25, s60, v11
    v_sub_f32 v24, v24, v32
    v_sub_f32 v25, v25, v32
    v_cvt_pk_bf16_f32 v24, v24, v25
    v_and_b32 v25, s60, v24
    v_lshlrev_b32 v24, 16, v24
    v_mul_f32 v24, v24, v34
    v_mul_f32 v25, v25, v34
    v_cvt_pk_bf16_f32 v24, v24, v25
    v_perm_b32 v42, v11, v24, s53
    v_perm_b32 v43, v11, v24, s52
    ds_write_b128 v6, v[36:39]
    ds_write_b128 v6, v[40:43] offset:16
    v_lshrrev_b32 v6, 1, v0
    v_lshlrev_b32 v6, 2, v6
    v_and_b32 v7, 1, v0
    v_mul_u32_u24 v7, 8256, v7
    v_add_u32 v6, v6, v7
    v_mov_b32 v33, 0
    s_lshl_b32 s51, s2, 7
    s_add_u32 s51, s51, 0xc10000
    s_cmp_ge_u32 s2, 80
    s_cbranch_scc1 M_NOZ
    s_cmp_lg_u32 s44, 1
    s_cbranch_scc1 M_NOZ
    s_mov_b64 exec, 1
    buffer_store_dword v33, v33, s[8:11], s51 offen sc1
    s_mov_b64 exec, -1
M_NOZ:
    s_waitcnt lgkmcnt(0)
    s_barrier
    ds_read_b32 v24, v6 offset:0
    ds_read_b32 v25, v6 offset:2064
    ds_read_b32 v26, v6 offset:4128
    ds_read_b32 v27, v6 offset:6192
    ds_read_b32 v28, v6 offset:1024
    ds_read_b32 v29, v6 offset:3088
    ds_read_b32 v30, v6 offset:5152
    ds_read_b32 v31, v6 offset:7216
    v_lshlrev_b32 v6, 4, v0
    s_lshl_b32 s51, s2, 14
    s_add_u32 s52, s51, 8192
    s_waitcnt lgkmcnt(4)
    buffer_store_dwordx4 v[24:27], v6, s[8:11], s51 offen sc1
    s_waitcnt lgkmcnt(0)
    buffer_store_dwordx4 v[28:31], v6, s[8:11], s52 offen sc1
    s_lshl_b32 s52, s46, 2
    s_load_dword s77, s[28:29], s52
    s_mov_b32 s80, s32
    s_and_b32 s81, s33, 0xffff
    s_mov_b32 s82, 0x158000
    s_mov_b32 s83, 0x00020000
    s_mov_b32 s84, s34
    s_and_b32 s85, s35, 0xffff
    s_mov_b32 s86, 0x158000
    s_mov_b32 s87, 0x00020000
    s_and_b32 s88, s44, 3
    s_lshl_b32 s89, s48, 1
    s_mul_i32 s90, s88, 3072
    s_mov_b32 s52, 43691
    s_mul_i32 s53, s88, 192
    s_add_u32 s53, s53, 0
    v_add_u32 v6, s53, v1
    v_mul_lo_u32 v7, v6, s52
    v_lshrrev_b32 v7, 19, v7
    v_mul_u32_u24 v8, 12, v7
    v_sub_u32 v6, v6, v8
    v_bfe_u32 v8, v7, 2, 1
    v_lshlrev_b32 v8, 1, v8
    v_xor_b32 v6, v6, v8
    v_mul_u32_u24 v7, 2752, v7
    v_lshl_add_u32 v244, v6, 4, v7
    s_mul_i32 s53, s88, 192
    s_add_u32 s53, s53, 64
    v_add_u32 v6, s53, v1
    v_mul_lo_u32 v7, v6, s52
    v_lshrrev_b32 v7, 19, v7
    v_mul_u32_u24 v8, 12, v7
    v_sub_u32 v6, v6, v8
    v_bfe_u32 v8, v7, 2, 1
    v_lshlrev_b32 v8, 1, v8
    v_xor_b32 v6, v6, v8
    v_mul_u32_u24 v7, 2752, v7
    v_lshl_add_u32 v245, v6, 4, v7
    s_mul_i32 s53, s88, 192
    s_add_u32 s53, s53, 128
    v_add_u32 v6, s53, v1
    v_mul_lo_u32 v7, v6, s52
    v_lshrrev_b32 v7, 19, v7
    v_mul_u32_u24 v8, 12, v7
    v_sub_u32 v6, v6, v8
    v_bfe_u32 v8, v7, 2, 1
    v_lshlrev_b32 v8, 1, v8
    v_xor_b32 v6, v6, v8
    v_mul_u32_u24 v7, 2752, v7
    v_lshl_add_u32 v246, v6, 4, v7
    s_cmp_lt_u32 s44, 4
    s_cselect_b32 s92, s80, s84
    s_cselect_b32 s93, s81, s85
    s_mov_b32 s94, s82
    s_mov_b32 s95, s83
    s_mul_i32 s91, s74, 12288
    s_add_u32 s91, s91, s90
    s_mov_b32 s52, 0x3fb8aa3b
    s_mov_b32 s53, 0x3e22f983
    v_lshlrev_b32 v16, 16, v16
    v_lshlrev_b32 v48, 16, v12
    v_and_b32 v52, s60, v12
    v_mul_f32 v16, s52, v16
    v_mul_f32 v48, s52, v48
    v_mul_f32 v52, s52, v52
    v_exp_f32 v16, v16
    v_exp_f32 v48, v48
    v_exp_f32 v52, v52
    v_lshlrev_b32 v49, 16, v13
    v_cvt_pk_bf16_f32 v16, v16, v16
    v_cvt_pk_bf16_f32 v48, v48, v52
    v_lshlrev_b32 v16, 16, v16
    v_and_b32 v52, s60, v48
    v_lshlrev_b32 v48, 16, v48
    v_and_b32 v53, s60, v13
    v_lshlrev_b32 v50, 16, v14
    v_and_b32 v54, s60, v14
    v_lshlrev_b32 v51, 16, v15
    v_and_b32 v55, s60, v15
    v_mul_f32 v48, v48, v16
    v_mul_f32 v49, v49, v16
    v_mul_f32 v50, v50, v16
    v_mul_f32 v51, v51, v16
    v_mul_f32 v52, v52, v16
    v_mul_f32 v53, v53, v16
    v_mul_f32 v54, v54, v16
    v_mul_f32 v55, v55, v16
    v_mul_f32 v48, s52, v48
    v_sub_f32 v48, 0, v48
    v_mul_f32 v49, s53, v49
    v_add_f32 v50, v50, v50
    v_add_f32 v51, v51, v51
    v_mul_f32 v52, s52, v52
    v_sub_f32 v52, 0, v52
    v_mul_f32 v53, s53, v53
    v_add_f32 v54, v54, v54
    v_add_f32 v55, v55, v55
    s_and_b32 s56, s44, 3
    s_mov_b32 s54, 0x41000000
    s_mov_b32 s55, 0x43000000
    s_cmp_eq_u32 s56, 1
    s_cselect_b32 s54, 1.0, s54
    s_cmp_eq_u32 s56, 2
    s_cselect_b32 s54, 2.0, s54
    s_cmp_eq_u32 s56, 3
    s_cselect_b32 s54, 0x44800000, s54
    s_cmp_eq_u32 s56, 0
    s_cselect_b32 s55, 0x42800000, s55
    s_cselect_b32 s57, -1.0, 1.0
    v_mul_f32 v56, s54, v48
    v_mul_f32 v57, s54, v49
    v_mul_f32 v58, s54, v52
    v_mul_f32 v59, s54, v53
    v_mul_f32 v60, s55, v48
    v_mul_f32 v61, s55, v49
    v_mul_f32 v62, s55, v52
    v_mul_f32 v63, s55, v53
    v_exp_f32 v56, v56
    v_fract_f32 v57, v57
    v_exp_f32 v58, v58
    v_fract_f32 v59, v59
    v_exp_f32 v60, v60
    v_fract_f32 v61, v61
    v_exp_f32 v62, v62
    v_fract_f32 v63, v63
    v_cos_f32 v64, v57
    v_sin_f32 v57, v57
    v_cos_f32 v65, v59
    v_sin_f32 v59, v59
    v_cos_f32 v66, v61
    v_sin_f32 v61, v61
    v_cos_f32 v67, v63
    v_sin_f32 v63, v63
    v_mul_f32 v68, v56, v57
    v_mul_f32 v56, v56, v64
    v_mul_f32 v69, v58, v59
    v_mul_f32 v58, v58, v65
    v_mul_f32 v70, v60, v61
    v_mul_f32 v60, v60, v66
    v_mul_f32 v71, v62, v63
    v_mul_f32 v62, v62, v67
    v_mul_f32 v57, s57, v68
    v_mul_f32 v59, s57, v69
    v_mul_f32 v61, s57, v70
    v_mul_f32 v63, s57, v71
    v_and_b32 v10, 7, v3
    v_lshrrev_b32 v18, 3, v3
    v_lshl_add_u32 v10, v18, 7, v10
    v_lshrrev_b32 v18, 2, v3
    v_lshlrev_b32 v18, 7, v18
    v_and_b32 v19, 3, v3
    v_lshl_add_u32 v18, v19, 1, v18
    v_add_u32 v18, 256, v18
    v_subrev_u32 v19, 8, v3
    v_lshrrev_b32 v19, 1, v19
    v_lshlrev_b32 v19, 7, v19
    v_and_b32 v20, 1, v3
    v_lshl_add_u32 v19, v20, 2, v19
    v_add_u32 v19, 512, v19
    v_cmp_gt_u32 vcc, 8, v3
    v_lshlrev_b32 v17, 7, v3
    v_add_u32 v17, 1024, v17
    v_cndmask_b32 v11, v19, v18, vcc
    v_lshlrev_b32 v18, 2, v3
    v_add_u32 v18, 0x27640, v18
    v_lshlrev_b32 v19, 1, v10
    v_lshlrev_b32 v20, 1, v11
    v_lshlrev_b32 v21, 1, v17
    ds_write_b32 v18, v19
    ds_write_b32 v18, v20 offset:64
    ds_write_b32 v18, v21 offset:128
    s_mul_i32 s58, s74, 90112
    v_lshl_add_u32 v6, v1, 2, s58
    s_waitcnt vmcnt(0) lgkmcnt(0)
    s_barrier
    s_cmp_lg_u32 s44, 0
    s_cbranch_scc1 PUB_1
    s_mov_b64 exec, 1
    s_and_b32 s96, s45, 1
    s_lshl_b32 s96, s96, 7
    v_mov_b32 v252, s96
    v_mov_b32 v253, 1
    buffer_atomic_add v253, v252, s[68:71], 0 offen sc1
    s_mov_b64 exec, -1
PUB_1:
    s_cmp_eq_u32 s56, 1
    s_cbranch_scc1 M_KW1
    s_cmp_eq_u32 s56, 2
    s_cbranch_scc1 M_KW2
    s_cmp_eq_u32 s56, 3
    s_cbranch_scc1 M_KW3
    v_mov_b32 v80, 1.0
    v_mov_b32 v81, 0
    v_mov_b32 v82, 1.0
    v_mov_b32 v83, 0
    v_cvt_pk_bf16_f32 v74, v80, v82
    v_lshlrev_b32 v76, 16, v74
    v_and_b32 v77, s60, v74
    v_sub_f32 v76, v80, v76
    v_sub_f32 v77, v82, v77
    v_cvt_pk_bf16_f32 v75, v76, v77
    ds_write_b32 v6, v74 offset:11152
    ds_write_b32 v6, v75 offset:26656
    v_cvt_pk_bf16_f32 v74, v81, v83
    v_lshlrev_b32 v76, 16, v74
    v_and_b32 v77, s60, v74
    v_sub_f32 v76, v81, v76
    v_sub_f32 v77, v83, v77
    v_cvt_pk_bf16_f32 v75, v76, v77
    ds_write_b32 v6, v74 offset:42160
    ds_write_b32 v6, v75 offset:57664
    v_cvt_pk_bf16_f32 v74, v56, v58
    v_lshlrev_b32 v76, 16, v74
    v_and_b32 v77, s60, v74
    v_sub_f32 v76, v56, v76
    v_sub_f32 v77, v58, v77
    v_cvt_pk_bf16_f32 v75, v76, v77
    ds_write_b32 v6, v74 offset:11424
    ds_write_b32 v6, v75 offset:26928
    v_cvt_pk_bf16_f32 v74, v57, v59
    v_lshlrev_b32 v76, 16, v74
    v_and_b32 v77, s60, v74
    v_sub_f32 v76, v57, v76
    v_sub_f32 v77, v59, v77
    v_cvt_pk_bf16_f32 v75, v76, v77
    ds_write_b32 v6, v74 offset:42432
    ds_write_b32 v6, v75 offset:57936
    v_cvt_pk_bf16_f32 v74, v60, v62
    v_lshlrev_b32 v76, 16, v74
    v_and_b32 v77, s60, v74
    v_sub_f32 v76, v60, v76
    v_sub_f32 v77, v62, v77
    v_cvt_pk_bf16_f32 v75, v76, v77
    ds_write_b32 v6, v74 offset:13328
    ds_write_b32 v6, v75 offset:28832
    v_cvt_pk_bf16_f32 v74, v61, v63
    v_lshlrev_b32 v76, 16, v74
    v_and_b32 v77, s60, v74
    v_sub_f32 v76, v61, v76
    v_sub_f32 v77, v63, v77
    v_cvt_pk_bf16_f32 v75, v76, v77
    ds_write_b32 v6, v74 offset:44336
    ds_write_b32 v6, v75 offset:59840
    v_mul_f32 v72, v57, v57
    v_mul_f32 v73, v56, v57
    v_fma_f32 v80, v56, v56, -v72
    v_add_f32 v81, v73, v73
    v_mul_f32 v72, v59, v59
    v_mul_f32 v73, v58, v59
    v_fma_f32 v82, v58, v58, -v72
    v_add_f32 v83, v73, v73
    v_cvt_pk_bf16_f32 v74, v80, v82
    v_lshlrev_b32 v76, 16, v74
    v_and_b32 v77, s60, v74
    v_sub_f32 v76, v80, v76
    v_sub_f32 v77, v82, v77
    v_cvt_pk_bf16_f32 v75, v76, v77
    ds_write_b32 v6, v74 offset:11696
    ds_write_b32 v6, v75 offset:27200
    v_cvt_pk_bf16_f32 v74, v81, v83
    v_lshlrev_b32 v76, 16, v74
    v_and_b32 v77, s60, v74
    v_sub_f32 v76, v81, v76
    v_sub_f32 v77, v83, v77
    v_cvt_pk_bf16_f32 v75, v76, v77
    ds_write_b32 v6, v74 offset:42704
    ds_write_b32 v6, v75 offset:58208
    v_mul_f32 v72, v61, v57
    v_mul_f32 v73, v60, v57
    v_fma_f32 v84, v60, v56, -v72
    v_fma_f32 v85, v61, v56, v73
    v_mul_f32 v72, v63, v59
    v_mul_f32 v73, v62, v59
    v_fma_f32 v86, v62, v58, -v72
    v_fma_f32 v87, v63, v58, v73
    v_cvt_pk_bf16_f32 v74, v84, v86
    v_lshlrev_b32 v76, 16, v74
    v_and_b32 v77, s60, v74
    v_sub_f32 v76, v84, v76
    v_sub_f32 v77, v86, v77
    v_cvt_pk_bf16_f32 v75, v76, v77
    ds_write_b32 v6, v74 offset:13600
    ds_write_b32 v6, v75 offset:29104
    v_cvt_pk_bf16_f32 v74, v85, v87
    v_lshlrev_b32 v76, 16, v74
    v_and_b32 v77, s60, v74
    v_sub_f32 v76, v85, v76
    v_sub_f32 v77, v87, v77
    v_cvt_pk_bf16_f32 v75, v76, v77
    ds_write_b32 v6, v74 offset:44608
    ds_write_b32 v6, v75 offset:60112
    v_mul_f32 v72, v81, v57
    v_mul_f32 v73, v80, v57
    v_fma_f32 v80, v80, v56, -v72
    v_fma_f32 v81, v81, v56, v73
    v_mul_f32 v72, v83, v59
    v_mul_f32 v73, v82, v59
    v_fma_f32 v82, v82, v58, -v72
    v_fma_f32 v83, v83, v58, v73
    v_cvt_pk_bf16_f32 v74, v80, v82
    v_lshlrev_b32 v76, 16, v74
    v_and_b32 v77, s60, v74
    v_sub_f32 v76, v80, v76
    v_sub_f32 v77, v82, v77
    v_cvt_pk_bf16_f32 v75, v76, v77
    ds_write_b32 v6, v74 offset:11968
    ds_write_b32 v6, v75 offset:27472
    v_cvt_pk_bf16_f32 v74, v81, v83
    v_lshlrev_b32 v76, 16, v74
    v_and_b32 v77, s60, v74
    v_sub_f32 v76, v81, v76
    v_sub_f32 v77, v83, v77
    v_cvt_pk_bf16_f32 v75, v76, v77
    ds_write_b32 v6, v74 offset:42976
    ds_write_b32 v6, v75 offset:58480
    v_mul_f32 v72, v85, v57
    v_mul_f32 v73, v84, v57
    v_fma_f32 v84, v84, v56, -v72
    v_fma_f32 v85, v85, v56, v73
    v_mul_f32 v72, v87, v59
    v_mul_f32 v73, v86, v59
    v_fma_f32 v86, v86, v58, -v72
    v_fma_f32 v87, v87, v58, v73
    v_cvt_pk_bf16_f32 v74, v84, v86
    v_lshlrev_b32 v76, 16, v74
    v_and_b32 v77, s60, v74
    v_sub_f32 v76, v84, v76
    v_sub_f32 v77, v86, v77
    v_cvt_pk_bf16_f32 v75, v76, v77
    ds_write_b32 v6, v74 offset:13872
    ds_write_b32 v6, v75 offset:29376
    v_cvt_pk_bf16_f32 v74, v85, v87
    v_lshlrev_b32 v76, 16, v74
    v_and_b32 v77, s60, v74
    v_sub_f32 v76, v85, v76
    v_sub_f32 v77, v87, v77
    v_cvt_pk_bf16_f32 v75, v76, v77
    ds_write_b32 v6, v74 offset:44880
    ds_write_b32 v6, v75 offset:60384
    v_mul_f32 v72, v81, v57
    v_mul_f32 v73, v80, v57
    v_fma_f32 v80, v80, v56, -v72
    v_fma_f32 v81, v81, v56, v73
    v_mul_f32 v72, v83, v59
    v_mul_f32 v73, v82, v59
    v_fma_f32 v82, v82, v58, -v72
    v_fma_f32 v83, v83, v58, v73
    v_cvt_pk_bf16_f32 v74, v80, v82
    v_lshlrev_b32 v76, 16, v74
    v_and_b32 v77, s60, v74
    v_sub_f32 v76, v80, v76
    v_sub_f32 v77, v82, v77
    v_cvt_pk_bf16_f32 v75, v76, v77
    ds_write_b32 v6, v74 offset:12240
    ds_write_b32 v6, v75 offset:27744
    v_cvt_pk_bf16_f32 v74, v81, v83
    v_lshlrev_b32 v76, 16, v74
    v_and_b32 v77, s60, v74
    v_sub_f32 v76, v81, v76
    v_sub_f32 v77, v83, v77
    v_cvt_pk_bf16_f32 v75, v76, v77
    ds_write_b32 v6, v74 offset:43248
    ds_write_b32 v6, v75 offset:58752
    v_mul_f32 v72, v85, v57
    v_mul_f32 v73, v84, v57
    v_fma_f32 v84, v84, v56, -v72
    v_fma_f32 v85, v85, v56, v73
    v_mul_f32 v72, v87, v59
    v_mul_f32 v73, v86, v59
    v_fma_f32 v86, v86, v58, -v72
    v_fma_f32 v87, v87, v58, v73
    v_cvt_pk_bf16_f32 v74, v84, v86
    v_lshlrev_b32 v76, 16, v74
    v_and_b32 v77, s60, v74
    v_sub_f32 v76, v84, v76
    v_sub_f32 v77, v86, v77
    v_cvt_pk_bf16_f32 v75, v76, v77
    ds_write_b32 v6, v74 offset:14144
    ds_write_b32 v6, v75 offset:29648
    v_cvt_pk_bf16_f32 v74, v85, v87
    v_lshlrev_b32 v76, 16, v74
    v_and_b32 v77, s60, v74
    v_sub_f32 v76, v85, v76
    v_sub_f32 v77, v87, v77
    v_cvt_pk_bf16_f32 v75, v76, v77
    ds_write_b32 v6, v74 offset:45152
    ds_write_b32 v6, v75 offset:60656
    v_mul_f32 v72, v81, v57
    v_mul_f32 v73, v80, v57
    v_fma_f32 v80, v80, v56, -v72
    v_fma_f32 v81, v81, v56, v73
    v_mul_f32 v72, v83, v59
    v_mul_f32 v73, v82, v59
    v_fma_f32 v82, v82, v58, -v72
    v_fma_f32 v83, v83, v58, v73
    v_cvt_pk_bf16_f32 v74, v80, v82
    v_lshlrev_b32 v76, 16, v74
    v_and_b32 v77, s60, v74
    v_sub_f32 v76, v80, v76
    v_sub_f32 v77, v82, v77
    v_cvt_pk_bf16_f32 v75, v76, v77
    ds_write_b32 v6, v74 offset:12512
    ds_write_b32 v6, v75 offset:28016
    v_cvt_pk_bf16_f32 v74, v81, v83
    v_lshlrev_b32 v76, 16, v74
    v_and_b32 v77, s60, v74
    v_sub_f32 v76, v81, v76
    v_sub_f32 v77, v83, v77
    v_cvt_pk_bf16_f32 v75, v76, v77
    ds_write_b32 v6, v74 offset:43520
    ds_write_b32 v6, v75 offset:59024
    v_mul_f32 v72, v85, v57
    v_mul_f32 v73, v84, v57
    v_fma_f32 v84, v84, v56, -v72
    v_fma_f32 v85, v85, v56, v73
    v_mul_f32 v72, v87, v59
    v_mul_f32 v73, v86, v59
    v_fma_f32 v86, v86, v58, -v72
    v_fma_f32 v87, v87, v58, v73
    v_cvt_pk_bf16_f32 v74, v84, v86
    v_lshlrev_b32 v76, 16, v74
    v_and_b32 v77, s60, v74
    v_sub_f32 v76, v84, v76
    v_sub_f32 v77, v86, v77
    v_cvt_pk_bf16_f32 v75, v76, v77
    ds_write_b32 v6, v74 offset:14416
    ds_write_b32 v6, v75 offset:29920
    v_cvt_pk_bf16_f32 v74, v85, v87
    v_lshlrev_b32 v76, 16, v74
    v_and_b32 v77, s60, v74
    v_sub_f32 v76, v85, v76
    v_sub_f32 v77, v87, v77
    v_cvt_pk_bf16_f32 v75, v76, v77
    ds_write_b32 v6, v74 offset:45424
    ds_write_b32 v6, v75 offset:60928
    v_mul_f32 v72, v81, v57
    v_mul_f32 v73, v80, v57
    v_fma_f32 v80, v80, v56, -v72
    v_fma_f32 v81, v81, v56, v73
    v_mul_f32 v72, v83, v59
    v_mul_f32 v73, v82, v59
    v_fma_f32 v82, v82, v58, -v72
    v_fma_f32 v83, v83, v58, v73
    v_cvt_pk_bf16_f32 v74, v80, v82
    v_lshlrev_b32 v76, 16, v74
    v_and_b32 v77, s60, v74
    v_sub_f32 v76, v80, v76
    v_sub_f32 v77, v82, v77
    v_cvt_pk_bf16_f32 v75, v76, v77
    ds_write_b32 v6, v74 offset:12784
    ds_write_b32 v6, v75 offset:28288
    v_cvt_pk_bf16_f32 v74, v81, v83
    v_lshlrev_b32 v76, 16, v74
    v_and_b32 v77, s60, v74
    v_sub_f32 v76, v81, v76
    v_sub_f32 v77, v83, v77
    v_cvt_pk_bf16_f32 v75, v76, v77
    ds_write_b32 v6, v74 offset:43792
    ds_write_b32 v6, v75 offset:59296
    v_mul_f32 v72, v85, v57
    v_mul_f32 v73, v84, v57
    v_fma_f32 v84, v84, v56, -v72
    v_fma_f32 v85, v85, v56, v73
    v_mul_f32 v72, v87, v59
    v_mul_f32 v73, v86, v59
    v_fma_f32 v86, v86, v58, -v72
    v_fma_f32 v87, v87, v58, v73
    v_cvt_pk_bf16_f32 v74, v84, v86
    v_lshlrev_b32 v76, 16, v74
    v_and_b32 v77, s60, v74
    v_sub_f32 v76, v84, v76
    v_sub_f32 v77, v86, v77
    v_cvt_pk_bf16_f32 v75, v76, v77
    ds_write_b32 v6, v74 offset:14688
    ds_write_b32 v6, v75 offset:30192
    v_cvt_pk_bf16_f32 v74, v85, v87
    v_lshlrev_b32 v76, 16, v74
    v_and_b32 v77, s60, v74
    v_sub_f32 v76, v85, v76
    v_sub_f32 v77, v87, v77
    v_cvt_pk_bf16_f32 v75, v76, v77
    ds_write_b32 v6, v74 offset:45696
    ds_write_b32 v6, v75 offset:61200
    v_mul_f32 v72, v81, v57
    v_mul_f32 v73, v80, v57
    v_fma_f32 v80, v80, v56, -v72
    v_fma_f32 v81, v81, v56, v73
    v_mul_f32 v72, v83, v59
    v_mul_f32 v73, v82, v59
    v_fma_f32 v82, v82, v58, -v72
    v_fma_f32 v83, v83, v58, v73
    v_cvt_pk_bf16_f32 v74, v80, v82
    v_lshlrev_b32 v76, 16, v74
    v_and_b32 v77, s60, v74
    v_sub_f32 v76, v80, v76
    v_sub_f32 v77, v82, v77
    v_cvt_pk_bf16_f32 v75, v76, v77
    ds_write_b32 v6, v74 offset:13056
    ds_write_b32 v6, v75 offset:28560
    v_cvt_pk_bf16_f32 v74, v81, v83
    v_lshlrev_b32 v76, 16, v74
    v_and_b32 v77, s60, v74
    v_sub_f32 v76, v81, v76
    v_sub_f32 v77, v83, v77
    v_cvt_pk_bf16_f32 v75, v76, v77
    ds_write_b32 v6, v74 offset:44064
    ds_write_b32 v6, v75 offset:59568
    v_mul_f32 v72, v85, v57
    v_mul_f32 v73, v84, v57
    v_fma_f32 v84, v84, v56, -v72
    v_fma_f32 v85, v85, v56, v73
    v_mul_f32 v72, v87, v59
    v_mul_f32 v73, v86, v59
    v_fma_f32 v86, v86, v58, -v72
    v_fma_f32 v87, v87, v58, v73
    v_cvt_pk_bf16_f32 v74, v84, v86
    v_lshlrev_b32 v76, 16, v74
    v_and_b32 v77, s60, v74
    v_sub_f32 v76, v84, v76
    v_sub_f32 v77, v86, v77
    v_cvt_pk_bf16_f32 v75, v76, v77
    ds_write_b32 v6, v74 offset:14960
    ds_write_b32 v6, v75 offset:30464
    v_cvt_pk_bf16_f32 v74, v85, v87
    v_lshlrev_b32 v76, 16, v74
    v_and_b32 v77, s60, v74
    v_sub_f32 v76, v85, v76
    v_sub_f32 v77, v87, v77
    v_cvt_pk_bf16_f32 v75, v76, v77
    ds_write_b32 v6, v74 offset:45968
    ds_write_b32 v6, v75 offset:61472
    v_mul_f32 v72, v85, v57
    v_mul_f32 v73, v84, v57
    v_fma_f32 v84, v84, v56, -v72
    v_fma_f32 v85, v85, v56, v73
    v_mul_f32 v72, v87, v59
    v_mul_f32 v73, v86, v59
    v_fma_f32 v86, v86, v58, -v72
    v_fma_f32 v87, v87, v58, v73
    v_cvt_pk_bf16_f32 v74, v84, v86
    v_lshlrev_b32 v76, 16, v74
    v_and_b32 v77, s60, v74
    v_sub_f32 v76, v84, v76
    v_sub_f32 v77, v86, v77
    v_cvt_pk_bf16_f32 v75, v76, v77
    ds_write_b32 v6, v74 offset:15232
    ds_write_b32 v6, v75 offset:30736
    v_cvt_pk_bf16_f32 v74, v85, v87
    v_lshlrev_b32 v76, 16, v74
    v_and_b32 v77, s60, v74
    v_sub_f32 v76, v85, v76
    v_sub_f32 v77, v87, v77
    v_cvt_pk_bf16_f32 v75, v76, v77
    ds_write_b32 v6, v74 offset:46240
    ds_write_b32 v6, v75 offset:61744
    s_branch M_KWE
M_KW1:
    v_mov_b32 v80, v50
    v_mov_b32 v81, v51
    v_mov_b32 v82, v54
    v_mov_b32 v83, v55
    v_cvt_pk_bf16_f32 v74, v80, v82
    v_lshlrev_b32 v76, 16, v74
    v_and_b32 v77, s60, v74
    v_sub_f32 v76, v80, v76
    v_sub_f32 v77, v82, v77
    v_cvt_pk_bf16_f32 v75, v76, v77
    ds_write_b32 v6, v74 offset:0
    ds_write_b32 v6, v75 offset:15504
    v_cvt_pk_bf16_f32 v74, v81, v83
    v_lshlrev_b32 v76, 16, v74
    v_and_b32 v77, s60, v74
    v_sub_f32 v76, v81, v76
    v_sub_f32 v77, v83, v77
    v_cvt_pk_bf16_f32 v75, v76, v77
    ds_write_b32 v6, v74 offset:31008
    ds_write_b32 v6, v75 offset:46512
    v_mul_f32 v72, v81, v61
    v_mul_f32 v73, v80, v61
    v_fma_f32 v84, v80, v60, -v72
    v_fma_f32 v85, v81, v60, v73
    v_mul_f32 v72, v83, v63
    v_mul_f32 v73, v82, v63
    v_fma_f32 v86, v82, v62, -v72
    v_fma_f32 v87, v83, v62, v73
    v_cvt_pk_bf16_f32 v74, v84, v86
    v_lshlrev_b32 v76, 16, v74
    v_and_b32 v77, s60, v74
    v_sub_f32 v76, v84, v76
    v_sub_f32 v77, v86, v77
    v_cvt_pk_bf16_f32 v75, v76, v77
    ds_write_b32 v6, v74 offset:2176
    ds_write_b32 v6, v75 offset:17680
    v_cvt_pk_bf16_f32 v74, v85, v87
    v_lshlrev_b32 v76, 16, v74
    v_and_b32 v77, s60, v74
    v_sub_f32 v76, v85, v76
    v_sub_f32 v77, v87, v77
    v_cvt_pk_bf16_f32 v75, v76, v77
    ds_write_b32 v6, v74 offset:33184
    ds_write_b32 v6, v75 offset:48688
    v_mul_f32 v72, v81, v57
    v_mul_f32 v73, v80, v57
    v_fma_f32 v80, v80, v56, -v72
    v_fma_f32 v81, v81, v56, v73
    v_mul_f32 v72, v83, v59
    v_mul_f32 v73, v82, v59
    v_fma_f32 v82, v82, v58, -v72
    v_fma_f32 v83, v83, v58, v73
    v_cvt_pk_bf16_f32 v74, v80, v82
    v_lshlrev_b32 v76, 16, v74
    v_and_b32 v77, s60, v74
    v_sub_f32 v76, v80, v76
    v_sub_f32 v77, v82, v77
    v_cvt_pk_bf16_f32 v75, v76, v77
    ds_write_b32 v6, v74 offset:272
    ds_write_b32 v6, v75 offset:15776
    v_cvt_pk_bf16_f32 v74, v81, v83
    v_lshlrev_b32 v76, 16, v74
    v_and_b32 v77, s60, v74
    v_sub_f32 v76, v81, v76
    v_sub_f32 v77, v83, v77
    v_cvt_pk_bf16_f32 v75, v76, v77
    ds_write_b32 v6, v74 offset:31280
    ds_write_b32 v6, v75 offset:46784
    v_mul_f32 v72, v81, v61
    v_mul_f32 v73, v80, v61
    v_fma_f32 v84, v80, v60, -v72
    v_fma_f32 v85, v81, v60, v73
    v_mul_f32 v72, v83, v63
    v_mul_f32 v73, v82, v63
    v_fma_f32 v86, v82, v62, -v72
    v_fma_f32 v87, v83, v62, v73
    v_cvt_pk_bf16_f32 v74, v84, v86
    v_lshlrev_b32 v76, 16, v74
    v_and_b32 v77, s60, v74
    v_sub_f32 v76, v84, v76
    v_sub_f32 v77, v86, v77
    v_cvt_pk_bf16_f32 v75, v76, v77
    ds_write_b32 v6, v74 offset:2448
    ds_write_b32 v6, v75 offset:17952
    v_cvt_pk_bf16_f32 v74, v85, v87
    v_lshlrev_b32 v76, 16, v74
    v_and_b32 v77, s60, v74
    v_sub_f32 v76, v85, v76
    v_sub_f32 v77, v87, v77
    v_cvt_pk_bf16_f32 v75, v76, v77
    ds_write_b32 v6, v74 offset:33456
    ds_write_b32 v6, v75 offset:48960
    v_mul_f32 v72, v81, v57
    v_mul_f32 v73, v80, v57
    v_fma_f32 v80, v80, v56, -v72
    v_fma_f32 v81, v81, v56, v73
    v_mul_f32 v72, v83, v59
    v_mul_f32 v73, v82, v59
    v_fma_f32 v82, v82, v58, -v72
    v_fma_f32 v83, v83, v58, v73
    v_cvt_pk_bf16_f32 v74, v80, v82
    v_lshlrev_b32 v76, 16, v74
    v_and_b32 v77, s60, v74
    v_sub_f32 v76, v80, v76
    v_sub_f32 v77, v82, v77
    v_cvt_pk_bf16_f32 v75, v76, v77
    ds_write_b32 v6, v74 offset:544
    ds_write_b32 v6, v75 offset:16048
    v_cvt_pk_bf16_f32 v74, v81, v83
    v_lshlrev_b32 v76, 16, v74
    v_and_b32 v77, s60, v74
    v_sub_f32 v76, v81, v76
    v_sub_f32 v77, v83, v77
    v_cvt_pk_bf16_f32 v75, v76, v77
    ds_write_b32 v6, v74 offset:31552
    ds_write_b32 v6, v75 offset:47056
    v_mul_f32 v72, v81, v61
    v_mul_f32 v73, v80, v61
    v_fma_f32 v84, v80, v60, -v72
    v_fma_f32 v85, v81, v60, v73
    v_mul_f32 v72, v83, v63
    v_mul_f32 v73, v82, v63
    v_fma_f32 v86, v82, v62, -v72
    v_fma_f32 v87, v83, v62, v73
    v_cvt_pk_bf16_f32 v74, v84, v86
    v_lshlrev_b32 v76, 16, v74
    v_and_b32 v77, s60, v74
    v_sub_f32 v76, v84, v76
    v_sub_f32 v77, v86, v77
    v_cvt_pk_bf16_f32 v75, v76, v77
    ds_write_b32 v6, v74 offset:2720
    ds_write_b32 v6, v75 offset:18224
    v_cvt_pk_bf16_f32 v74, v85, v87
    v_lshlrev_b32 v76, 16, v74
    v_and_b32 v77, s60, v74
    v_sub_f32 v76, v85, v76
    v_sub_f32 v77, v87, v77
    v_cvt_pk_bf16_f32 v75, v76, v77
    ds_write_b32 v6, v74 offset:33728
    ds_write_b32 v6, v75 offset:49232
    v_mul_f32 v72, v81, v57
    v_mul_f32 v73, v80, v57
    v_fma_f32 v80, v80, v56, -v72
    v_fma_f32 v81, v81, v56, v73
    v_mul_f32 v72, v83, v59
    v_mul_f32 v73, v82, v59
    v_fma_f32 v82, v82, v58, -v72
    v_fma_f32 v83, v83, v58, v73
    v_cvt_pk_bf16_f32 v74, v80, v82
    v_lshlrev_b32 v76, 16, v74
    v_and_b32 v77, s60, v74
    v_sub_f32 v76, v80, v76
    v_sub_f32 v77, v82, v77
    v_cvt_pk_bf16_f32 v75, v76, v77
    ds_write_b32 v6, v74 offset:816
    ds_write_b32 v6, v75 offset:16320
    v_cvt_pk_bf16_f32 v74, v81, v83
    v_lshlrev_b32 v76, 16, v74
    v_and_b32 v77, s60, v74
    v_sub_f32 v76, v81, v76
    v_sub_f32 v77, v83, v77
    v_cvt_pk_bf16_f32 v75, v76, v77
    ds_write_b32 v6, v74 offset:31824
    ds_write_b32 v6, v75 offset:47328
    v_mul_f32 v72, v81, v61
    v_mul_f32 v73, v80, v61
    v_fma_f32 v84, v80, v60, -v72
    v_fma_f32 v85, v81, v60, v73
    v_mul_f32 v72, v83, v63
    v_mul_f32 v73, v82, v63
    v_fma_f32 v86, v82, v62, -v72
    v_fma_f32 v87, v83, v62, v73
    v_cvt_pk_bf16_f32 v74, v84, v86
    v_lshlrev_b32 v76, 16, v74
    v_and_b32 v77, s60, v74
    v_sub_f32 v76, v84, v76
    v_sub_f32 v77, v86, v77
    v_cvt_pk_bf16_f32 v75, v76, v77
    ds_write_b32 v6, v74 offset:2992
    ds_write_b32 v6, v75 offset:18496
    v_cvt_pk_bf16_f32 v74, v85, v87
    v_lshlrev_b32 v76, 16, v74
    v_and_b32 v77, s60, v74
    v_sub_f32 v76, v85, v76
    v_sub_f32 v77, v87, v77
    v_cvt_pk_bf16_f32 v75, v76, v77
    ds_write_b32 v6, v74 offset:34000
    ds_write_b32 v6, v75 offset:49504
    v_mul_f32 v72, v81, v57
    v_mul_f32 v73, v80, v57
    v_fma_f32 v80, v80, v56, -v72
    v_fma_f32 v81, v81, v56, v73
    v_mul_f32 v72, v83, v59
    v_mul_f32 v73, v82, v59
    v_fma_f32 v82, v82, v58, -v72
    v_fma_f32 v83, v83, v58, v73
    v_cvt_pk_bf16_f32 v74, v80, v82
    v_lshlrev_b32 v76, 16, v74
    v_and_b32 v77, s60, v74
    v_sub_f32 v76, v80, v76
    v_sub_f32 v77, v82, v77
    v_cvt_pk_bf16_f32 v75, v76, v77
    ds_write_b32 v6, v74 offset:1088
    ds_write_b32 v6, v75 offset:16592
    v_cvt_pk_bf16_f32 v74, v81, v83
    v_lshlrev_b32 v76, 16, v74
    v_and_b32 v77, s60, v74
    v_sub_f32 v76, v81, v76
    v_sub_f32 v77, v83, v77
    v_cvt_pk_bf16_f32 v75, v76, v77
    ds_write_b32 v6, v74 offset:32096
    ds_write_b32 v6, v75 offset:47600
    v_mul_f32 v72, v81, v61
    v_mul_f32 v73, v80, v61
    v_fma_f32 v84, v80, v60, -v72
    v_fma_f32 v85, v81, v60, v73
    v_mul_f32 v72, v83, v63
    v_mul_f32 v73, v82, v63
    v_fma_f32 v86, v82, v62, -v72
    v_fma_f32 v87, v83, v62, v73
    v_cvt_pk_bf16_f32 v74, v84, v86
    v_lshlrev_b32 v76, 16, v74
    v_and_b32 v77, s60, v74
    v_sub_f32 v76, v84, v76
    v_sub_f32 v77, v86, v77
    v_cvt_pk_bf16_f32 v75, v76, v77
    ds_write_b32 v6, v74 offset:3264
    ds_write_b32 v6, v75 offset:18768
    v_cvt_pk_bf16_f32 v74, v85, v87
    v_lshlrev_b32 v76, 16, v74
    v_and_b32 v77, s60, v74
    v_sub_f32 v76, v85, v76
    v_sub_f32 v77, v87, v77
    v_cvt_pk_bf16_f32 v75, v76, v77
    ds_write_b32 v6, v74 offset:34272
    ds_write_b32 v6, v75 offset:49776
    v_mul_f32 v72, v81, v57
    v_mul_f32 v73, v80, v57
    v_fma_f32 v80, v80, v56, -v72
    v_fma_f32 v81, v81, v56, v73
    v_mul_f32 v72, v83, v59
    v_mul_f32 v73, v82, v59
    v_fma_f32 v82, v82, v58, -v72
    v_fma_f32 v83, v83, v58, v73
    v_cvt_pk_bf16_f32 v74, v80, v82
    v_lshlrev_b32 v76, 16, v74
    v_and_b32 v77, s60, v74
    v_sub_f32 v76, v80, v76
    v_sub_f32 v77, v82, v77
    v_cvt_pk_bf16_f32 v75, v76, v77
    ds_write_b32 v6, v74 offset:1360
    ds_write_b32 v6, v75 offset:16864
    v_cvt_pk_bf16_f32 v74, v81, v83
    v_lshlrev_b32 v76, 16, v74
    v_and_b32 v77, s60, v74
    v_sub_f32 v76, v81, v76
    v_sub_f32 v77, v83, v77
    v_cvt_pk_bf16_f32 v75, v76, v77
    ds_write_b32 v6, v74 offset:32368
    ds_write_b32 v6, v75 offset:47872
    v_mul_f32 v72, v81, v61
    v_mul_f32 v73, v80, v61
    v_fma_f32 v84, v80, v60, -v72
    v_fma_f32 v85, v81, v60, v73
    v_mul_f32 v72, v83, v63
    v_mul_f32 v73, v82, v63
    v_fma_f32 v86, v82, v62, -v72
    v_fma_f32 v87, v83, v62, v73
    v_cvt_pk_bf16_f32 v74, v84, v86
    v_lshlrev_b32 v76, 16, v74
    v_and_b32 v77, s60, v74
    v_sub_f32 v76, v84, v76
    v_sub_f32 v77, v86, v77
    v_cvt_pk_bf16_f32 v75, v76, v77
    ds_write_b32 v6, v74 offset:3536
    ds_write_b32 v6, v75 offset:19040
    v_cvt_pk_bf16_f32 v74, v85, v87
    v_lshlrev_b32 v76, 16, v74
    v_and_b32 v77, s60, v74
    v_sub_f32 v76, v85, v76
    v_sub_f32 v77, v87, v77
    v_cvt_pk_bf16_f32 v75, v76, v77
    ds_write_b32 v6, v74 offset:34544
    ds_write_b32 v6, v75 offset:50048
    v_mul_f32 v72, v81, v57
    v_mul_f32 v73, v80, v57
    v_fma_f32 v80, v80, v56, -v72
    v_fma_f32 v81, v81, v56, v73
    v_mul_f32 v72, v83, v59
    v_mul_f32 v73, v82, v59
    v_fma_f32 v82, v82, v58, -v72
    v_fma_f32 v83, v83, v58, v73
    v_cvt_pk_bf16_f32 v74, v80, v82
    v_lshlrev_b32 v76, 16, v74
    v_and_b32 v77, s60, v74
    v_sub_f32 v76, v80, v76
    v_sub_f32 v77, v82, v77
    v_cvt_pk_bf16_f32 v75, v76, v77
    ds_write_b32 v6, v74 offset:1632
    ds_write_b32 v6, v75 offset:17136
    v_cvt_pk_bf16_f32 v74, v81, v83
    v_lshlrev_b32 v76, 16, v74
    v_and_b32 v77, s60, v74
    v_sub_f32 v76, v81, v76
    v_sub_f32 v77, v83, v77
    v_cvt_pk_bf16_f32 v75, v76, v77
    ds_write_b32 v6, v74 offset:32640
    ds_write_b32 v6, v75 offset:48144
    v_mul_f32 v72, v81, v61
    v_mul_f32 v73, v80, v61
    v_fma_f32 v84, v80, v60, -v72
    v_fma_f32 v85, v81, v60, v73
    v_mul_f32 v72, v83, v63
    v_mul_f32 v73, v82, v63
    v_fma_f32 v86, v82, v62, -v72
    v_fma_f32 v87, v83, v62, v73
    v_cvt_pk_bf16_f32 v74, v84, v86
    v_lshlrev_b32 v76, 16, v74
    v_and_b32 v77, s60, v74
    v_sub_f32 v76, v84, v76
    v_sub_f32 v77, v86, v77
    v_cvt_pk_bf16_f32 v75, v76, v77
    ds_write_b32 v6, v74 offset:3808
    ds_write_b32 v6, v75 offset:19312
    v_cvt_pk_bf16_f32 v74, v85, v87
    v_lshlrev_b32 v76, 16, v74
    v_and_b32 v77, s60, v74
    v_sub_f32 v76, v85, v76
    v_sub_f32 v77, v87, v77
    v_cvt_pk_bf16_f32 v75, v76, v77
    ds_write_b32 v6, v74 offset:34816
    ds_write_b32 v6, v75 offset:50320
    v_mul_f32 v72, v81, v57
    v_mul_f32 v73, v80, v57
    v_fma_f32 v80, v80, v56, -v72
    v_fma_f32 v81, v81, v56, v73
    v_mul_f32 v72, v83, v59
    v_mul_f32 v73, v82, v59
    v_fma_f32 v82, v82, v58, -v72
    v_fma_f32 v83, v83, v58, v73
    v_cvt_pk_bf16_f32 v74, v80, v82
    v_lshlrev_b32 v76, 16, v74
    v_and_b32 v77, s60, v74
    v_sub_f32 v76, v80, v76
    v_sub_f32 v77, v82, v77
    v_cvt_pk_bf16_f32 v75, v76, v77
    ds_write_b32 v6, v74 offset:1904
    ds_write_b32 v6, v75 offset:17408
    v_cvt_pk_bf16_f32 v74, v81, v83
    v_lshlrev_b32 v76, 16, v74
    v_and_b32 v77, s60, v74
    v_sub_f32 v76, v81, v76
    v_sub_f32 v77, v83, v77
    v_cvt_pk_bf16_f32 v75, v76, v77
    ds_write_b32 v6, v74 offset:32912
    ds_write_b32 v6, v75 offset:48416
    v_mul_f32 v72, v81, v61
    v_mul_f32 v73, v80, v61
    v_fma_f32 v84, v80, v60, -v72
    v_fma_f32 v85, v81, v60, v73
    v_mul_f32 v72, v83, v63
    v_mul_f32 v73, v82, v63
    v_fma_f32 v86, v82, v62, -v72
    v_fma_f32 v87, v83, v62, v73
    v_cvt_pk_bf16_f32 v74, v84, v86
    v_lshlrev_b32 v76, 16, v74
    v_and_b32 v77, s60, v74
    v_sub_f32 v76, v84, v76
    v_sub_f32 v77, v86, v77
    v_cvt_pk_bf16_f32 v75, v76, v77
    ds_write_b32 v6, v74 offset:4080
    ds_write_b32 v6, v75 offset:19584
    v_cvt_pk_bf16_f32 v74, v85, v87
    v_lshlrev_b32 v76, 16, v74
    v_and_b32 v77, s60, v74
    v_sub_f32 v76, v85, v76
    v_sub_f32 v77, v87, v77
    v_cvt_pk_bf16_f32 v75, v76, v77
    ds_write_b32 v6, v74 offset:35088
    ds_write_b32 v6, v75 offset:50592
    s_branch M_KWE
M_KW2:
    v_mul_f32 v72, v61, v61
    v_mul_f32 v73, v60, v61
    v_fma_f32 v88, v60, v60, -v72
    v_add_f32 v89, v73, v73
    v_mul_f32 v72, v63, v63
    v_mul_f32 v73, v62, v63
    v_fma_f32 v90, v62, v62, -v72
    v_add_f32 v91, v73, v73
    v_mov_b32 v84, v50
    v_mov_b32 v85, v51
    v_mov_b32 v86, v54
    v_mov_b32 v87, v55
    v_mul_f32 v72, v85, v89
    v_mul_f32 v73, v84, v89
    v_fma_f32 v80, v84, v88, -v72
    v_fma_f32 v81, v85, v88, v73
    v_mul_f32 v72, v87, v91
    v_mul_f32 v73, v86, v91
    v_fma_f32 v82, v86, v90, -v72
    v_fma_f32 v83, v87, v90, v73
    v_cvt_pk_bf16_f32 v74, v80, v82
    v_lshlrev_b32 v76, 16, v74
    v_and_b32 v77, s60, v74
    v_sub_f32 v76, v80, v76
    v_sub_f32 v77, v82, v77
    v_cvt_pk_bf16_f32 v75, v76, v77
    ds_write_b32 v6, v74 offset:4352
    ds_write_b32 v6, v75 offset:19856
    v_cvt_pk_bf16_f32 v74, v81, v83
    v_lshlrev_b32 v76, 16, v74
    v_and_b32 v77, s60, v74
    v_sub_f32 v76, v81, v76
    v_sub_f32 v77, v83, v77
    v_cvt_pk_bf16_f32 v75, v76, v77
    ds_write_b32 v6, v74 offset:35360
    ds_write_b32 v6, v75 offset:50864
    v_mul_f32 v72, v81, v61
    v_mul_f32 v73, v80, v61
    v_fma_f32 v84, v80, v60, -v72
    v_fma_f32 v85, v81, v60, v73
    v_mul_f32 v72, v83, v63
    v_mul_f32 v73, v82, v63
    v_fma_f32 v86, v82, v62, -v72
    v_fma_f32 v87, v83, v62, v73
    v_cvt_pk_bf16_f32 v74, v84, v86
    v_lshlrev_b32 v76, 16, v74
    v_and_b32 v77, s60, v74
    v_sub_f32 v76, v84, v76
    v_sub_f32 v77, v86, v77
    v_cvt_pk_bf16_f32 v75, v76, v77
    ds_write_b32 v6, v74 offset:5440
    ds_write_b32 v6, v75 offset:20944
    v_cvt_pk_bf16_f32 v74, v85, v87
    v_lshlrev_b32 v76, 16, v74
    v_and_b32 v77, s60, v74
    v_sub_f32 v76, v85, v76
    v_sub_f32 v77, v87, v77
    v_cvt_pk_bf16_f32 v75, v76, v77
    ds_write_b32 v6, v74 offset:36448
    ds_write_b32 v6, v75 offset:51952
    v_mul_f32 v72, v81, v57
    v_mul_f32 v73, v80, v57
    v_fma_f32 v80, v80, v56, -v72
    v_fma_f32 v81, v81, v56, v73
    v_mul_f32 v72, v83, v59
    v_mul_f32 v73, v82, v59
    v_fma_f32 v82, v82, v58, -v72
    v_fma_f32 v83, v83, v58, v73
    v_cvt_pk_bf16_f32 v74, v80, v82
    v_lshlrev_b32 v76, 16, v74
    v_and_b32 v77, s60, v74
    v_sub_f32 v76, v80, v76
    v_sub_f32 v77, v82, v77
    v_cvt_pk_bf16_f32 v75, v76, v77
    ds_write_b32 v6, v74 offset:4624
    ds_write_b32 v6, v75 offset:20128
    v_cvt_pk_bf16_f32 v74, v81, v83
    v_lshlrev_b32 v76, 16, v74
    v_and_b32 v77, s60, v74
    v_sub_f32 v76, v81, v76
    v_sub_f32 v77, v83, v77
    v_cvt_pk_bf16_f32 v75, v76, v77
    ds_write_b32 v6, v74 offset:35632
    ds_write_b32 v6, v75 offset:51136
    v_mul_f32 v72, v81, v61
    v_mul_f32 v73, v80, v61
    v_fma_f32 v84, v80, v60, -v72
    v_fma_f32 v85, v81, v60, v73
    v_mul_f32 v72, v83, v63
    v_mul_f32 v73, v82, v63
    v_fma_f32 v86, v82, v62, -v72
    v_fma_f32 v87, v83, v62, v73
    v_cvt_pk_bf16_f32 v74, v84, v86
    v_lshlrev_b32 v76, 16, v74
    v_and_b32 v77, s60, v74
    v_sub_f32 v76, v84, v76
    v_sub_f32 v77, v86, v77
    v_cvt_pk_bf16_f32 v75, v76, v77
    ds_write_b32 v6, v74 offset:5712
    ds_write_b32 v6, v75 offset:21216
    v_cvt_pk_bf16_f32 v74, v85, v87
    v_lshlrev_b32 v76, 16, v74
    v_and_b32 v77, s60, v74
    v_sub_f32 v76, v85, v76
    v_sub_f32 v77, v87, v77
    v_cvt_pk_bf16_f32 v75, v76, v77
    ds_write_b32 v6, v74 offset:36720
    ds_write_b32 v6, v75 offset:52224
    v_mul_f32 v72, v81, v57
    v_mul_f32 v73, v80, v57
    v_fma_f32 v80, v80, v56, -v72
    v_fma_f32 v81, v81, v56, v73
    v_mul_f32 v72, v83, v59
    v_mul_f32 v73, v82, v59
    v_fma_f32 v82, v82, v58, -v72
    v_fma_f32 v83, v83, v58, v73
    v_cvt_pk_bf16_f32 v74, v80, v82
    v_lshlrev_b32 v76, 16, v74
    v_and_b32 v77, s60, v74
    v_sub_f32 v76, v80, v76
    v_sub_f32 v77, v82, v77
    v_cvt_pk_bf16_f32 v75, v76, v77
    ds_write_b32 v6, v74 offset:4896
    ds_write_b32 v6, v75 offset:20400
    v_cvt_pk_bf16_f32 v74, v81, v83
    v_lshlrev_b32 v76, 16, v74
    v_and_b32 v77, s60, v74
    v_sub_f32 v76, v81, v76
    v_sub_f32 v77, v83, v77
    v_cvt_pk_bf16_f32 v75, v76, v77
    ds_write_b32 v6, v74 offset:35904
    ds_write_b32 v6, v75 offset:51408
    v_mul_f32 v72, v81, v61
    v_mul_f32 v73, v80, v61
    v_fma_f32 v84, v80, v60, -v72
    v_fma_f32 v85, v81, v60, v73
    v_mul_f32 v72, v83, v63
    v_mul_f32 v73, v82, v63
    v_fma_f32 v86, v82, v62, -v72
    v_fma_f32 v87, v83, v62, v73
    v_cvt_pk_bf16_f32 v74, v84, v86
    v_lshlrev_b32 v76, 16, v74
    v_and_b32 v77, s60, v74
    v_sub_f32 v76, v84, v76
    v_sub_f32 v77, v86, v77
    v_cvt_pk_bf16_f32 v75, v76, v77
    ds_write_b32 v6, v74 offset:5984
    ds_write_b32 v6, v75 offset:21488
    v_cvt_pk_bf16_f32 v74, v85, v87
    v_lshlrev_b32 v76, 16, v74
    v_and_b32 v77, s60, v74
    v_sub_f32 v76, v85, v76
    v_sub_f32 v77, v87, v77
    v_cvt_pk_bf16_f32 v75, v76, v77
    ds_write_b32 v6, v74 offset:36992
    ds_write_b32 v6, v75 offset:52496
    v_mul_f32 v72, v81, v57
    v_mul_f32 v73, v80, v57
    v_fma_f32 v80, v80, v56, -v72
    v_fma_f32 v81, v81, v56, v73
    v_mul_f32 v72, v83, v59
    v_mul_f32 v73, v82, v59
    v_fma_f32 v82, v82, v58, -v72
    v_fma_f32 v83, v83, v58, v73
    v_cvt_pk_bf16_f32 v74, v80, v82
    v_lshlrev_b32 v76, 16, v74
    v_and_b32 v77, s60, v74
    v_sub_f32 v76, v80, v76
    v_sub_f32 v77, v82, v77
    v_cvt_pk_bf16_f32 v75, v76, v77
    ds_write_b32 v6, v74 offset:5168
    ds_write_b32 v6, v75 offset:20672
    v_cvt_pk_bf16_f32 v74, v81, v83
    v_lshlrev_b32 v76, 16, v74
    v_and_b32 v77, s60, v74
    v_sub_f32 v76, v81, v76
    v_sub_f32 v77, v83, v77
    v_cvt_pk_bf16_f32 v75, v76, v77
    ds_write_b32 v6, v74 offset:36176
    ds_write_b32 v6, v75 offset:51680
    v_mul_f32 v72, v81, v61
    v_mul_f32 v73, v80, v61
    v_fma_f32 v84, v80, v60, -v72
    v_fma_f32 v85, v81, v60, v73
    v_mul_f32 v72, v83, v63
    v_mul_f32 v73, v82, v63
    v_fma_f32 v86, v82, v62, -v72
    v_fma_f32 v87, v83, v62, v73
    v_cvt_pk_bf16_f32 v74, v84, v86
    v_lshlrev_b32 v76, 16, v74
    v_and_b32 v77, s60, v74
    v_sub_f32 v76, v84, v76
    v_sub_f32 v77, v86, v77
    v_cvt_pk_bf16_f32 v75, v76, v77
    ds_write_b32 v6, v74 offset:6256
    ds_write_b32 v6, v75 offset:21760
    v_cvt_pk_bf16_f32 v74, v85, v87
    v_lshlrev_b32 v76, 16, v74
    v_and_b32 v77, s60, v74
    v_sub_f32 v76, v85, v76
    v_sub_f32 v77, v87, v77
    v_cvt_pk_bf16_f32 v75, v76, v77
    ds_write_b32 v6, v74 offset:37264
    ds_write_b32 v6, v75 offset:52768
    v_mul_f32 v72, v89, v89
    v_mul_f32 v73, v88, v89
    v_fma_f32 v88, v88, v88, -v72
    v_add_f32 v89, v73, v73
    v_mul_f32 v72, v91, v91
    v_mul_f32 v73, v90, v91
    v_fma_f32 v90, v90, v90, -v72
    v_add_f32 v91, v73, v73
    v_mul_f32 v72, v57, v57
    v_mul_f32 v73, v56, v57
    v_fma_f32 v56, v56, v56, -v72
    v_add_f32 v57, v73, v73
    v_mul_f32 v72, v59, v59
    v_mul_f32 v73, v58, v59
    v_fma_f32 v58, v58, v58, -v72
    v_add_f32 v59, v73, v73
    v_mov_b32 v84, v50
    v_mov_b32 v85, v51
    v_mov_b32 v86, v54
    v_mov_b32 v87, v55
    v_mul_f32 v72, v85, v89
    v_mul_f32 v73, v84, v89
    v_fma_f32 v80, v84, v88, -v72
    v_fma_f32 v81, v85, v88, v73
    v_mul_f32 v72, v87, v91
    v_mul_f32 v73, v86, v91
    v_fma_f32 v82, v86, v90, -v72
    v_fma_f32 v83, v87, v90, v73
    v_mul_f32 v72, v81, v57
    v_mul_f32 v73, v80, v57
    v_fma_f32 v84, v80, v56, -v72
    v_fma_f32 v85, v81, v56, v73
    v_mul_f32 v72, v83, v59
    v_mul_f32 v73, v82, v59
    v_fma_f32 v86, v82, v58, -v72
    v_fma_f32 v87, v83, v58, v73
    v_cvt_pk_bf16_f32 v74, v80, v82
    v_lshlrev_b32 v76, 16, v74
    v_and_b32 v77, s60, v74
    v_sub_f32 v76, v80, v76
    v_sub_f32 v77, v82, v77
    v_cvt_pk_bf16_f32 v75, v76, v77
    ds_write_b32 v6, v74 offset:6528
    ds_write_b32 v6, v75 offset:22032
    v_cvt_pk_bf16_f32 v74, v81, v83
    v_lshlrev_b32 v76, 16, v74
    v_and_b32 v77, s60, v74
    v_sub_f32 v76, v81, v76
    v_sub_f32 v77, v83, v77
    v_cvt_pk_bf16_f32 v75, v76, v77
    ds_write_b32 v6, v74 offset:37536
    ds_write_b32 v6, v75 offset:53040
    v_cvt_pk_bf16_f32 v74, v84, v86
    v_lshlrev_b32 v76, 16, v74
    v_and_b32 v77, s60, v74
    v_sub_f32 v76, v84, v76
    v_sub_f32 v77, v86, v77
    v_cvt_pk_bf16_f32 v75, v76, v77
    ds_write_b32 v6, v74 offset:6800
    ds_write_b32 v6, v75 offset:22304
    v_cvt_pk_bf16_f32 v74, v85, v87
    v_lshlrev_b32 v76, 16, v74
    v_and_b32 v77, s60, v74
    v_sub_f32 v76, v85, v76
    v_sub_f32 v77, v87, v77
    v_cvt_pk_bf16_f32 v75, v76, v77
    ds_write_b32 v6, v74 offset:37808
    ds_write_b32 v6, v75 offset:53312
    v_mul_f32 v72, v81, v61
    v_mul_f32 v73, v80, v61
    v_fma_f32 v80, v80, v60, -v72
    v_fma_f32 v81, v81, v60, v73
    v_mul_f32 v72, v83, v63
    v_mul_f32 v73, v82, v63
    v_fma_f32 v82, v82, v62, -v72
    v_fma_f32 v83, v83, v62, v73
    v_mul_f32 v72, v85, v61
    v_mul_f32 v73, v84, v61
    v_fma_f32 v84, v84, v60, -v72
    v_fma_f32 v85, v85, v60, v73
    v_mul_f32 v72, v87, v63
    v_mul_f32 v73, v86, v63
    v_fma_f32 v86, v86, v62, -v72
    v_fma_f32 v87, v87, v62, v73
    v_cvt_pk_bf16_f32 v74, v80, v82
    v_lshlrev_b32 v76, 16, v74
    v_and_b32 v77, s60, v74
    v_sub_f32 v76, v80, v76
    v_sub_f32 v77, v82, v77
    v_cvt_pk_bf16_f32 v75, v76, v77
    ds_write_b32 v6, v74 offset:7072
    ds_write_b32 v6, v75 offset:22576
    v_cvt_pk_bf16_f32 v74, v81, v83
    v_lshlrev_b32 v76, 16, v74
    v_and_b32 v77, s60, v74
    v_sub_f32 v76, v81, v76
    v_sub_f32 v77, v83, v77
    v_cvt_pk_bf16_f32 v75, v76, v77
    ds_write_b32 v6, v74 offset:38080
    ds_write_b32 v6, v75 offset:53584
    v_cvt_pk_bf16_f32 v74, v84, v86
    v_lshlrev_b32 v76, 16, v74
    v_and_b32 v77, s60, v74
    v_sub_f32 v76, v84, v76
    v_sub_f32 v77, v86, v77
    v_cvt_pk_bf16_f32 v75, v76, v77
    ds_write_b32 v6, v74 offset:7344
    ds_write_b32 v6, v75 offset:22848
    v_cvt_pk_bf16_f32 v74, v85, v87
    v_lshlrev_b32 v76, 16, v74
    v_and_b32 v77, s60, v74
    v_sub_f32 v76, v85, v76
    v_sub_f32 v77, v87, v77
    v_cvt_pk_bf16_f32 v75, v76, v77
    ds_write_b32 v6, v74 offset:38352
    ds_write_b32 v6, v75 offset:53856
    v_mul_f32 v72, v81, v61
    v_mul_f32 v73, v80, v61
    v_fma_f32 v80, v80, v60, -v72
    v_fma_f32 v81, v81, v60, v73
    v_mul_f32 v72, v83, v63
    v_mul_f32 v73, v82, v63
    v_fma_f32 v82, v82, v62, -v72
    v_fma_f32 v83, v83, v62, v73
    v_mul_f32 v72, v85, v61
    v_mul_f32 v73, v84, v61
    v_fma_f32 v84, v84, v60, -v72
    v_fma_f32 v85, v85, v60, v73
    v_mul_f32 v72, v87, v63
    v_mul_f32 v73, v86, v63
    v_fma_f32 v86, v86, v62, -v72
    v_fma_f32 v87, v87, v62, v73
    v_cvt_pk_bf16_f32 v74, v80, v82
    v_lshlrev_b32 v76, 16, v74
    v_and_b32 v77, s60, v74
    v_sub_f32 v76, v80, v76
    v_sub_f32 v77, v82, v77
    v_cvt_pk_bf16_f32 v75, v76, v77
    ds_write_b32 v6, v74 offset:7616
    ds_write_b32 v6, v75 offset:23120
    v_cvt_pk_bf16_f32 v74, v81, v83
    v_lshlrev_b32 v76, 16, v74
    v_and_b32 v77, s60, v74
    v_sub_f32 v76, v81, v76
    v_sub_f32 v77, v83, v77
    v_cvt_pk_bf16_f32 v75, v76, v77
    ds_write_b32 v6, v74 offset:38624
    ds_write_b32 v6, v75 offset:54128
    v_cvt_pk_bf16_f32 v74, v84, v86
    v_lshlrev_b32 v76, 16, v74
    v_and_b32 v77, s60, v74
    v_sub_f32 v76, v84, v76
    v_sub_f32 v77, v86, v77
    v_cvt_pk_bf16_f32 v75, v76, v77
    ds_write_b32 v6, v74 offset:7888
    ds_write_b32 v6, v75 offset:23392
    v_cvt_pk_bf16_f32 v74, v85, v87
    v_lshlrev_b32 v76, 16, v74
    v_and_b32 v77, s60, v74
    v_sub_f32 v76, v85, v76
    v_sub_f32 v77, v87, v77
    v_cvt_pk_bf16_f32 v75, v76, v77
    ds_write_b32 v6, v74 offset:38896
    ds_write_b32 v6, v75 offset:54400
    v_mul_f32 v72, v81, v61
    v_mul_f32 v73, v80, v61
    v_fma_f32 v80, v80, v60, -v72
    v_fma_f32 v81, v81, v60, v73
    v_mul_f32 v72, v83, v63
    v_mul_f32 v73, v82, v63
    v_fma_f32 v82, v82, v62, -v72
    v_fma_f32 v83, v83, v62, v73
    v_mul_f32 v72, v85, v61
    v_mul_f32 v73, v84, v61
    v_fma_f32 v84, v84, v60, -v72
    v_fma_f32 v85, v85, v60, v73
    v_mul_f32 v72, v87, v63
    v_mul_f32 v73, v86, v63
    v_fma_f32 v86, v86, v62, -v72
    v_fma_f32 v87, v87, v62, v73
    v_cvt_pk_bf16_f32 v74, v80, v82
    v_lshlrev_b32 v76, 16, v74
    v_and_b32 v77, s60, v74
    v_sub_f32 v76, v80, v76
    v_sub_f32 v77, v82, v77
    v_cvt_pk_bf16_f32 v75, v76, v77
    ds_write_b32 v6, v74 offset:8160
    ds_write_b32 v6, v75 offset:23664
    v_cvt_pk_bf16_f32 v74, v81, v83
    v_lshlrev_b32 v76, 16, v74
    v_and_b32 v77, s60, v74
    v_sub_f32 v76, v81, v76
    v_sub_f32 v77, v83, v77
    v_cvt_pk_bf16_f32 v75, v76, v77
    ds_write_b32 v6, v74 offset:39168
    ds_write_b32 v6, v75 offset:54672
    v_cvt_pk_bf16_f32 v74, v84, v86
    v_lshlrev_b32 v76, 16, v74
    v_and_b32 v77, s60, v74
    v_sub_f32 v76, v84, v76
    v_sub_f32 v77, v86, v77
    v_cvt_pk_bf16_f32 v75, v76, v77
    ds_write_b32 v6, v74 offset:8432
    ds_write_b32 v6, v75 offset:23936
    v_cvt_pk_bf16_f32 v74, v85, v87
    v_lshlrev_b32 v76, 16, v74
    v_and_b32 v77, s60, v74
    v_sub_f32 v76, v85, v76
    v_sub_f32 v77, v87, v77
    v_cvt_pk_bf16_f32 v75, v76, v77
    ds_write_b32 v6, v74 offset:39440
    ds_write_b32 v6, v75 offset:54944
    s_branch M_KWE
M_KW3:
    v_mov_b32 v84, v50
    v_mov_b32 v85, v51
    v_mov_b32 v86, v54
    v_mov_b32 v87, v55
    v_mul_f32 v72, v85, v57
    v_mul_f32 v73, v84, v57
    v_fma_f32 v80, v84, v56, -v72
    v_fma_f32 v81, v85, v56, v73
    v_mul_f32 v72, v87, v59
    v_mul_f32 v73, v86, v59
    v_fma_f32 v82, v86, v58, -v72
    v_fma_f32 v83, v87, v58, v73
    v_cvt_pk_bf16_f32 v74, v80, v82
    v_lshlrev_b32 v76, 16, v74
    v_and_b32 v77, s60, v74
    v_sub_f32 v76, v80, v76
    v_sub_f32 v77, v82, v77
    v_cvt_pk_bf16_f32 v75, v76, v77
    ds_write_b32 v6, v74 offset:8704
    ds_write_b32 v6, v75 offset:24208
    v_cvt_pk_bf16_f32 v74, v81, v83
    v_lshlrev_b32 v76, 16, v74
    v_and_b32 v77, s60, v74
    v_sub_f32 v76, v81, v76
    v_sub_f32 v77, v83, v77
    v_cvt_pk_bf16_f32 v75, v76, v77
    ds_write_b32 v6, v74 offset:39712
    ds_write_b32 v6, v75 offset:55216
    v_mul_f32 v72, v81, v61
    v_mul_f32 v73, v80, v61
    v_fma_f32 v80, v80, v60, -v72
    v_fma_f32 v81, v81, v60, v73
    v_mul_f32 v72, v83, v63
    v_mul_f32 v73, v82, v63
    v_fma_f32 v82, v82, v62, -v72
    v_fma_f32 v83, v83, v62, v73
    v_cvt_pk_bf16_f32 v74, v80, v82
    v_lshlrev_b32 v76, 16, v74
    v_and_b32 v77, s60, v74
    v_sub_f32 v76, v80, v76
    v_sub_f32 v77, v82, v77
    v_cvt_pk_bf16_f32 v75, v76, v77
    ds_write_b32 v6, v74 offset:8976
    ds_write_b32 v6, v75 offset:24480
    v_cvt_pk_bf16_f32 v74, v81, v83
    v_lshlrev_b32 v76, 16, v74
    v_and_b32 v77, s60, v74
    v_sub_f32 v76, v81, v76
    v_sub_f32 v77, v83, v77
    v_cvt_pk_bf16_f32 v75, v76, v77
    ds_write_b32 v6, v74 offset:39984
    ds_write_b32 v6, v75 offset:55488
    v_mul_f32 v72, v81, v61
    v_mul_f32 v73, v80, v61
    v_fma_f32 v80, v80, v60, -v72
    v_fma_f32 v81, v81, v60, v73
    v_mul_f32 v72, v83, v63
    v_mul_f32 v73, v82, v63
    v_fma_f32 v82, v82, v62, -v72
    v_fma_f32 v83, v83, v62, v73
    v_cvt_pk_bf16_f32 v74, v80, v82
    v_lshlrev_b32 v76, 16, v74
    v_and_b32 v77, s60, v74
    v_sub_f32 v76, v80, v76
    v_sub_f32 v77, v82, v77
    v_cvt_pk_bf16_f32 v75, v76, v77
    ds_write_b32 v6, v74 offset:9248
    ds_write_b32 v6, v75 offset:24752
    v_cvt_pk_bf16_f32 v74, v81, v83
    v_lshlrev_b32 v76, 16, v74
    v_and_b32 v77, s60, v74
    v_sub_f32 v76, v81, v76
    v_sub_f32 v77, v83, v77
    v_cvt_pk_bf16_f32 v75, v76, v77
    ds_write_b32 v6, v74 offset:40256
    ds_write_b32 v6, v75 offset:55760
    v_mul_f32 v72, v81, v61
    v_mul_f32 v73, v80, v61
    v_fma_f32 v80, v80, v60, -v72
    v_fma_f32 v81, v81, v60, v73
    v_mul_f32 v72, v83, v63
    v_mul_f32 v73, v82, v63
    v_fma_f32 v82, v82, v62, -v72
    v_fma_f32 v83, v83, v62, v73
    v_cvt_pk_bf16_f32 v74, v80, v82
    v_lshlrev_b32 v76, 16, v74
    v_and_b32 v77, s60, v74
    v_sub_f32 v76, v80, v76
    v_sub_f32 v77, v82, v77
    v_cvt_pk_bf16_f32 v75, v76, v77
    ds_write_b32 v6, v74 offset:9520
    ds_write_b32 v6, v75 offset:25024
    v_cvt_pk_bf16_f32 v74, v81, v83
    v_lshlrev_b32 v76, 16, v74
    v_and_b32 v77, s60, v74
    v_sub_f32 v76, v81, v76
    v_sub_f32 v77, v83, v77
    v_cvt_pk_bf16_f32 v75, v76, v77
    ds_write_b32 v6, v74 offset:40528
    ds_write_b32 v6, v75 offset:56032
    v_mul_f32 v72, v81, v61
    v_mul_f32 v73, v80, v61
    v_fma_f32 v80, v80, v60, -v72
    v_fma_f32 v81, v81, v60, v73
    v_mul_f32 v72, v83, v63
    v_mul_f32 v73, v82, v63
    v_fma_f32 v82, v82, v62, -v72
    v_fma_f32 v83, v83, v62, v73
    v_cvt_pk_bf16_f32 v74, v80, v82
    v_lshlrev_b32 v76, 16, v74
    v_and_b32 v77, s60, v74
    v_sub_f32 v76, v80, v76
    v_sub_f32 v77, v82, v77
    v_cvt_pk_bf16_f32 v75, v76, v77
    ds_write_b32 v6, v74 offset:9792
    ds_write_b32 v6, v75 offset:25296
    v_cvt_pk_bf16_f32 v74, v81, v83
    v_lshlrev_b32 v76, 16, v74
    v_and_b32 v77, s60, v74
    v_sub_f32 v76, v81, v76
    v_sub_f32 v77, v83, v77
    v_cvt_pk_bf16_f32 v75, v76, v77
    ds_write_b32 v6, v74 offset:40800
    ds_write_b32 v6, v75 offset:56304
    v_mul_f32 v72, v81, v61
    v_mul_f32 v73, v80, v61
    v_fma_f32 v80, v80, v60, -v72
    v_fma_f32 v81, v81, v60, v73
    v_mul_f32 v72, v83, v63
    v_mul_f32 v73, v82, v63
    v_fma_f32 v82, v82, v62, -v72
    v_fma_f32 v83, v83, v62, v73
    v_cvt_pk_bf16_f32 v74, v80, v82
    v_lshlrev_b32 v76, 16, v74
    v_and_b32 v77, s60, v74
    v_sub_f32 v76, v80, v76
    v_sub_f32 v77, v82, v77
    v_cvt_pk_bf16_f32 v75, v76, v77
    ds_write_b32 v6, v74 offset:10064
    ds_write_b32 v6, v75 offset:25568
    v_cvt_pk_bf16_f32 v74, v81, v83
    v_lshlrev_b32 v76, 16, v74
    v_and_b32 v77, s60, v74
    v_sub_f32 v76, v81, v76
    v_sub_f32 v77, v83, v77
    v_cvt_pk_bf16_f32 v75, v76, v77
    ds_write_b32 v6, v74 offset:41072
    ds_write_b32 v6, v75 offset:56576
    v_mul_f32 v72, v81, v61
    v_mul_f32 v73, v80, v61
    v_fma_f32 v80, v80, v60, -v72
    v_fma_f32 v81, v81, v60, v73
    v_mul_f32 v72, v83, v63
    v_mul_f32 v73, v82, v63
    v_fma_f32 v82, v82, v62, -v72
    v_fma_f32 v83, v83, v62, v73
    v_cvt_pk_bf16_f32 v74, v80, v82
    v_lshlrev_b32 v76, 16, v74
    v_and_b32 v77, s60, v74
    v_sub_f32 v76, v80, v76
    v_sub_f32 v77, v82, v77
    v_cvt_pk_bf16_f32 v75, v76, v77
    ds_write_b32 v6, v74 offset:10336
    ds_write_b32 v6, v75 offset:25840
    v_cvt_pk_bf16_f32 v74, v81, v83
    v_lshlrev_b32 v76, 16, v74
    v_and_b32 v77, s60, v74
    v_sub_f32 v76, v81, v76
    v_sub_f32 v77, v83, v77
    v_cvt_pk_bf16_f32 v75, v76, v77
    ds_write_b32 v6, v74 offset:41344
    ds_write_b32 v6, v75 offset:56848
    v_mul_f32 v72, v81, v61
    v_mul_f32 v73, v80, v61
    v_fma_f32 v80, v80, v60, -v72
    v_fma_f32 v81, v81, v60, v73
    v_mul_f32 v72, v83, v63
    v_mul_f32 v73, v82, v63
    v_fma_f32 v82, v82, v62, -v72
    v_fma_f32 v83, v83, v62, v73
    v_cvt_pk_bf16_f32 v74, v80, v82
    v_lshlrev_b32 v76, 16, v74
    v_and_b32 v77, s60, v74
    v_sub_f32 v76, v80, v76
    v_sub_f32 v77, v82, v77
    v_cvt_pk_bf16_f32 v75, v76, v77
    ds_write_b32 v6, v74 offset:10608
    ds_write_b32 v6, v75 offset:26112
    v_cvt_pk_bf16_f32 v74, v81, v83
    v_lshlrev_b32 v76, 16, v74
    v_and_b32 v77, s60, v74
    v_sub_f32 v76, v81, v76
    v_sub_f32 v77, v83, v77
    v_cvt_pk_bf16_f32 v75, v76, v77
    ds_write_b32 v6, v74 offset:41616
    ds_write_b32 v6, v75 offset:57120
    v_mul_f32 v72, v81, v61
    v_mul_f32 v73, v80, v61
    v_fma_f32 v80, v80, v60, -v72
    v_fma_f32 v81, v81, v60, v73
    v_mul_f32 v72, v83, v63
    v_mul_f32 v73, v82, v63
    v_fma_f32 v82, v82, v62, -v72
    v_fma_f32 v83, v83, v62, v73
    v_cvt_pk_bf16_f32 v74, v80, v82
    v_lshlrev_b32 v76, 16, v74
    v_and_b32 v77, s60, v74
    v_sub_f32 v76, v80, v76
    v_sub_f32 v77, v82, v77
    v_cvt_pk_bf16_f32 v75, v76, v77
    ds_write_b32 v6, v74 offset:10880
    ds_write_b32 v6, v75 offset:26384
    v_cvt_pk_bf16_f32 v74, v81, v83
    v_lshlrev_b32 v76, 16, v74
    v_and_b32 v77, s60, v74
    v_sub_f32 v76, v81, v76
    v_sub_f32 v77, v83, v77
    v_cvt_pk_bf16_f32 v75, v76, v77
    ds_write_b32 v6, v74 offset:41888
    ds_write_b32 v6, v75 offset:57392
M_KWE:
    s_lshl_b32 s52, s56, 4
    v_add_u32 v7, s52, v3
    v_mul_u32_u24 v7, 272, v7
    v_lshl_add_u32 v7, v4, 4, v7
    v_add_u32 v7, s58, v7
    v_add_u32 v8, 41, v3
    v_mul_u32_u24 v8, 272, v8
    v_lshl_add_u32 v8, v4, 4, v8
    v_add_u32 v8, s58, v8
    s_lshl_b32 s52, s56, 6
    v_lshl_add_u32 v9, v4, 4, s52
    v_add_u32 v9, 0x27640, v9
    s_mul_i32 s53, s74, 4608
    s_add_u32 s53, s53, 152128
    v_mov_b32 v56, 0
    v_mov_b32 v57, 0
    v_mov_b32 v58, 0
    v_mov_b32 v59, 0
    s_waitcnt lgkmcnt(0)
    s_barrier
    s_cmp_eq_u32 s56, 3
    s_cbranch_scc1 M_KM3
    ds_read_b128 v[64:67], v7 offset:0
    ds_read_b128 v[68:71], v7 offset:15504
    ds_read_b128 v[72:75], v7 offset:31008
    ds_read_b128 v[76:79], v7 offset:46512
    ds_read_b128 v[80:83], v8 offset:0
    ds_read_b128 v[84:87], v8 offset:15504
    ds_read_b128 v[88:91], v8 offset:31008
    ds_read_b128 v[92:95], v8 offset:46512
    ds_read_b128 v[60:63], v9
    ds_read_b128 v[96:99], v7 offset:64
    ds_read_b128 v[100:103], v7 offset:15568
    ds_read_b128 v[104:107], v7 offset:31072
    ds_read_b128 v[108:111], v7 offset:46576
    ds_read_b128 v[112:115], v8 offset:64
    ds_read_b128 v[116:119], v8 offset:15568
    ds_read_b128 v[120:123], v8 offset:31072
    ds_read_b128 v[124:127], v8 offset:46576
    ds_read_b128 v[128:131], v7 offset:128
    ds_read_b128 v[132:135], v7 offset:15632
    ds_read_b128 v[136:139], v7 offset:31136
    ds_read_b128 v[140:143], v7 offset:46640
    ds_read_b128 v[144:147], v8 offset:128
    ds_read_b128 v[148:151], v8 offset:15632
    ds_read_b128 v[152:155], v8 offset:31136
    ds_read_b128 v[156:159], v8 offset:46640
    ds_read_b128 v[160:163], v7 offset:192
    ds_read_b128 v[164:167], v7 offset:15696
    ds_read_b128 v[168:171], v7 offset:31200
    ds_read_b128 v[172:175], v7 offset:46704
    ds_read_b128 v[176:179], v8 offset:192
    ds_read_b128 v[180:183], v8 offset:15696
    ds_read_b128 v[184:187], v8 offset:31200
    ds_read_b128 v[188:191], v8 offset:46704
    v_lshl_add_u32 v10, v3, 4, s53
    s_add_u32 s52, s53, 4352
    s_waitcnt lgkmcnt(15)
    v_mfma_f32_16x16x32_bf16 v[56:59], v[64:67], v[80:83], v[56:59]
    v_mfma_f32_16x16x32_bf16 v[56:59], v[64:67], v[84:87], v[56:59]
    v_mfma_f32_16x16x32_bf16 v[56:59], v[68:71], v[80:83], v[56:59]
    v_mfma_f32_16x16x32_bf16 v[56:59], v[72:75], v[88:91], v[56:59]
    v_mfma_f32_16x16x32_bf16 v[56:59], v[72:75], v[92:95], v[56:59]
    v_mfma_f32_16x16x32_bf16 v[56:59], v[76:79], v[88:91], v[56:59]
    s_waitcnt lgkmcnt(15)
    v_mfma_f32_16x16x32_bf16 v[56:59], v[96:99], v[112:115], v[56:59]
    v_mfma_f32_16x16x32_bf16 v[56:59], v[96:99], v[116:119], v[56:59]
    v_mfma_f32_16x16x32_bf16 v[56:59], v[100:103], v[112:115], v[56:59]
    v_mfma_f32_16x16x32_bf16 v[56:59], v[104:107], v[120:123], v[56:59]
    v_mfma_f32_16x16x32_bf16 v[56:59], v[104:107], v[124:127], v[56:59]
    v_mfma_f32_16x16x32_bf16 v[56:59], v[108:111], v[120:123], v[56:59]
    s_waitcnt lgkmcnt(8)
    v_mfma_f32_16x16x32_bf16 v[56:59], v[128:131], v[144:147], v[56:59]
    v_mfma_f32_16x16x32_bf16 v[56:59], v[128:131], v[148:151], v[56:59]
    v_mfma_f32_16x16x32_bf16 v[56:59], v[132:135], v[144:147], v[56:59]
    v_mfma_f32_16x16x32_bf16 v[56:59], v[136:139], v[152:155], v[56:59]
    v_mfma_f32_16x16x32_bf16 v[56:59], v[136:139], v[156:159], v[56:59]
    v_mfma_f32_16x16x32_bf16 v[56:59], v[140:143], v[152:155], v[56:59]
    s_waitcnt lgkmcnt(0)
    v_mfma_f32_16x16x32_bf16 v[56:59], v[160:163], v[176:179], v[56:59]
    v_mfma_f32_16x16x32_bf16 v[56:59], v[160:163], v[180:183], v[56:59]
    v_mfma_f32_16x16x32_bf16 v[56:59], v[164:167], v[176:179], v[56:59]
    v_mfma_f32_16x16x32_bf16 v[56:59], v[168:171], v[184:187], v[56:59]
    v_mfma_f32_16x16x32_bf16 v[56:59], v[168:171], v[188:191], v[56:59]
    v_mfma_f32_16x16x32_bf16 v[56:59], v[172:175], v[184:187], v[56:59]
    v_add_u32 v60, v60, v10
    v_min_u32 v60, s52, v60
    v_add_u32 v61, v61, v10
    v_min_u32 v61, s52, v61
    v_add_u32 v62, v62, v10
    v_min_u32 v62, s52, v62
    v_add_u32 v63, v63, v10
    v_min_u32 v63, s52, v63
    s_nop 3
    v_cvt_pk_bf16_f32 v56, v56, v57
    v_cvt_pk_bf16_f32 v58, v58, v59
    ds_write_b16 v60, v56
    ds_write_b16_d16_hi v61, v56
    ds_write_b16 v62, v58
    ds_write_b16_d16_hi v63, v58
    s_branch M_KME
M_KM3:
    s_cmp_lg_u32 s44, 3
    s_cbranch_scc1 M_KME
    v_and_b32 v252, 1, v1
    v_lshlrev_b32 v252, 7, v252
    s_mov_b32 s96, 128
    s_mov_b32 s97, 0
POLL_2:
    buffer_load_dword v253, v252, s[68:71], 0 offen sc1
    s_waitcnt vmcnt(0)
    v_cmp_ne_u32 vcc, s96, v253
    s_add_u32 s97, s97, 1
    s_nop 3
    s_cmp_eq_u64 vcc, 0
    s_cbranch_scc1 POLLE_3
    s_cmp_gt_u32 s97, 0x200000
    s_cbranch_scc1 POLLE_3
    s_sleep 1
    s_branch POLL_2
POLLE_3:
M_KME:
    v_and_b32 v5, 255, v0
    v_lshlrev_b32 v6, 3, v5
    v_sub_u32 v6, 2047, v6
    v_subrev_u32 v24, 0, v6
    v_cvt_f32_i32 v24, v24
    v_subrev_u32 v25, 1, v6
    v_cvt_f32_i32 v25, v25
    v_subrev_u32 v26, 2, v6
    v_cvt_f32_i32 v26, v26
    v_subrev_u32 v27, 3, v6
    v_cvt_f32_i32 v27, v27
    v_subrev_u32 v28, 4, v6
    v_cvt_f32_i32 v28, v28
    v_subrev_u32 v29, 5, v6
    v_cvt_f32_i32 v29, v29
    v_subrev_u32 v30, 6, v6
    v_cvt_f32_i32 v30, v30
    v_subrev_u32 v31, 7, v6
    v_cvt_f32_i32 v31, v31
    v_subrev_u32 v32, 8, v6
    v_cvt_f32_i32 v32, v32
    v_subrev_u32 v33, 9, v6
    v_cvt_f32_i32 v33, v33
    v_subrev_u32 v34, 10, v6
    v_cvt_f32_i32 v34, v34
    v_subrev_u32 v35, 10, v6
    v_cvt_f32_i32 v35, v35
    v_cvt_pk_bf16_f32 v40, v24, v25
    v_cvt_pk_bf16_f32 v41, v26, v27
    v_cvt_pk_bf16_f32 v42, v28, v29
    v_cvt_pk_bf16_f32 v43, v30, v31
    v_cvt_pk_bf16_f32 v44, v32, v33
    v_cvt_pk_bf16_f32 v45, v34, v35
    v_lshlrev_b32 v24, 16, v40
    v_and_b32 v25, 0xffff0000, v40
    v_lshlrev_b32 v26, 16, v41
    v_and_b32 v27, 0xffff0000, v41
    v_lshlrev_b32 v28, 16, v42
    v_and_b32 v29, 0xffff0000, v42
    v_lshlrev_b32 v30, 16, v43
    v_and_b32 v31, 0xffff0000, v43
    v_lshlrev_b32 v32, 16, v44
    v_and_b32 v33, 0xffff0000, v44
    v_lshlrev_b32 v34, 16, v45
    v_cvt_u32_f32 v24, v24
    v_lshl_add_u32 v24, v24, 1, s53
    v_cvt_u32_f32 v25, v25
    v_lshl_add_u32 v25, v25, 1, s53
    v_cvt_u32_f32 v26, v26
    v_lshl_add_u32 v26, v26, 1, s53
    v_cvt_u32_f32 v27, v27
    v_lshl_add_u32 v27, v27, 1, s53
    v_cvt_u32_f32 v28, v28
    v_lshl_add_u32 v28, v28, 1, s53
    v_cvt_u32_f32 v29, v29
    v_lshl_add_u32 v29, v29, 1, s53
    v_cvt_u32_f32 v30, v30
    v_lshl_add_u32 v30, v30, 1, s53
    v_cvt_u32_f32 v31, v31
    v_lshl_add_u32 v31, v31, 1, s53
    v_cvt_u32_f32 v32, v32
    v_lshl_add_u32 v32, v32, 1, s53
    v_cvt_u32_f32 v33, v33
    v_lshl_add_u32 v33, v33, 1, s53
    v_cvt_u32_f32 v34, v34
    v_lshl_add_u32 v34, v34, 1, s53
    v_lshl_add_u32 v7, v5, 4, s75
    v_lshrrev_b32 v8, 2, v0
    v_and_b32 v9, 3, v0
    v_lshlrev_b32 v10, 14, v8
    v_lshl_add_u32 v10, v9, 4, v10
    s_lshl_b32 s52, s46, 6
    s_add_u32 s54, s52, 0x200000
    s_waitcnt lgkmcnt(0)
    s_barrier
    buffer_load_dwordx4 v[96:99], v10, s[8:11], s52 offen sc1
    buffer_load_dwordx4 v[100:103], v10, s[8:11], s54 offen sc1
    ds_read_u16 v44, v24
    ds_read_u16 v45, v25
    ds_read_u16 v46, v26
    ds_read_u16 v47, v27
    ds_read_u16 v48, v28
    ds_read_u16 v49, v29
    ds_read_u16 v50, v30
    ds_read_u16 v51, v31
    ds_read_u16 v52, v32
    ds_read_u16 v53, v33
    ds_read_u16 v54, v34
    v_lshlrev_b32 v8, 4, v8
    v_and_b32 v10, 1, v9
    v_lshl_add_u32 v8, v10, 3, v8
    v_lshrrev_b32 v9, 1, v9
    v_mul_u32_u24 v9, 25856, v9
    v_add_u32 v11, v8, v9
    v_mov_b32 v64, 0
    v_mov_b32 v65, 0
    v_mov_b32 v66, 0
    v_mov_b32 v67, 0
    v_cmp_eq_u32 vcc, 255, v5
    v_lshl_add_u32 v8, v1, 4, s75
    v_lshrrev_b32 v9, 2, v1
    v_mul_u32_u24 v9, 4160, v9
    v_and_b32 v10, 3, v1
    v_lshl_add_u32 v9, v10, 4, v9
    v_add_u32 v9, s75, v9
    s_waitcnt lgkmcnt(0)
    v_cndmask_b32 v52, v52, v64, vcc
    v_cndmask_b32 v53, v53, v64, vcc
    v_cndmask_b32 v54, v54, v64, vcc
    v_lshl_or_b32 v68, v45, 16, v44
    v_lshl_or_b32 v69, v47, 16, v46
    v_lshl_or_b32 v70, v49, 16, v48
    v_lshl_or_b32 v71, v51, 16, v50
    ds_write_b128 v7, v[68:71] offset:0
    v_lshl_or_b32 v72, v46, 16, v45
    v_lshl_or_b32 v73, v48, 16, v47
    v_lshl_or_b32 v74, v50, 16, v49
    v_lshl_or_b32 v75, v52, 16, v51
    ds_write_b128 v7, v[72:75] offset:4160
    v_lshl_or_b32 v76, v47, 16, v46
    v_lshl_or_b32 v77, v49, 16, v48
    v_lshl_or_b32 v78, v51, 16, v50
    v_lshl_or_b32 v79, v53, 16, v52
    ds_write_b128 v7, v[76:79] offset:8320
    v_lshl_or_b32 v80, v48, 16, v47
    v_lshl_or_b32 v81, v50, 16, v49
    v_lshl_or_b32 v82, v52, 16, v51
    v_lshl_or_b32 v83, v54, 16, v53
    ds_write_b128 v7, v[80:83] offset:12480
    ds_write_b128 v8, v[64:67] offset:16640
    v_cmp_gt_u32 vcc, 16, v1
    s_and_saveexec_b64 s[54:55], vcc
    ds_write_b128 v9, v[64:67] offset:4096
    s_mov_b64 exec, s[54:55]
    s_mov_b32 s52, 0x07060302
    s_mov_b32 s53, 0x05040100
    s_waitcnt vmcnt(1)
    v_perm_b32 v16, v97, v96, s53
    v_perm_b32 v17, v99, v98, s53
    v_perm_b32 v18, v97, v96, s52
    v_perm_b32 v19, v99, v98, s52
    ds_write_b64 v11, v[16:17] offset:17664
    ds_write_b64 v11, v[18:19] offset:21760
    s_waitcnt vmcnt(0)
    v_perm_b32 v16, v101, v100, s53
    v_perm_b32 v17, v103, v102, s53
    v_perm_b32 v18, v101, v100, s52
    v_perm_b32 v19, v103, v102, s52
    ds_write_b64 v11, v[16:17] offset:19712
    ds_write_b64 v11, v[18:19] offset:23808
    s_bfe_u32 s50, s44, 0x10001
    s_and_b32 s51, s44, 1
    v_and_b32 v14, 3, v3
    v_sub_u32 v14, 3, v14
    v_mul_u32_u24 v14, 4160, v14
    v_lshrrev_b32 v15, 2, v3
    v_lshlrev_b32 v15, 3, v15
    v_sub_u32 v14, v14, v15
    v_lshl_add_u32 v14, v4, 4, v14
    s_lshl_b32 s52, s51, 9
    s_sub_u32 s53, s75, s52
    s_lshl_b32 s54, s50, 5
    s_sub_u32 s54, s53, s54
    s_add_u32 s54, s54, 568
    v_add_u32 v14, s54, v14
    v_lshlrev_b32 v15, 6, v3
    v_lshl_add_u32 v15, v4, 4, v15
    s_add_u32 s53, s53, 17216
    v_add_u32 v15, s53, v15
    v_mov_b32 v16, 0
    v_mov_b32 v17, 0
    v_mov_b32 v18, 0
    v_mov_b32 v19, 0
    v_mov_b32 v20, 0
    v_mov_b32 v21, 0
    v_mov_b32 v22, 0
    v_mov_b32 v23, 0
    v_mov_b32 v24, 0
    v_mov_b32 v25, 0
    v_mov_b32 v26, 0
    v_mov_b32 v27, 0
    v_mov_b32 v28, 0
    v_mov_b32 v29, 0
    v_mov_b32 v30, 0
    v_mov_b32 v31, 0
    s_waitcnt lgkmcnt(0)
    s_barrier
    ds_read_b128 v[32:35], v15 offset:448
    ds_read_b128 v[36:39], v15 offset:1472
    ds_read_b128 v[40:43], v15 offset:2496
    ds_read_b128 v[44:47], v15 offset:3520
    ds_read_b64 v[48:49], v14 offset:3520
    ds_read_b64 v[50:51], v14 offset:3528
    ds_read_b64 v[52:53], v14 offset:2496
    ds_read_b64 v[54:55], v14 offset:2504
    ds_read_b64 v[56:57], v14 offset:1472
    ds_read_b64 v[58:59], v14 offset:1480
    ds_read_b64 v[60:61], v14 offset:448
    ds_read_b64 v[62:63], v14 offset:456
    s_waitcnt lgkmcnt(0)
    ds_read_b128 v[64:67], v15 offset:384
    v_mfma_f32_16x16x32_bf16 v[16:19], v[48:51], v[32:35], v[16:19]
    ds_read_b128 v[68:71], v15 offset:1408
    v_mfma_f32_16x16x32_bf16 v[20:23], v[48:51], v[36:39], v[20:23]
    ds_read_b128 v[72:75], v15 offset:2432
    v_mfma_f32_16x16x32_bf16 v[24:27], v[48:51], v[40:43], v[24:27]
    ds_read_b128 v[76:79], v15 offset:3456
    v_mfma_f32_16x16x32_bf16 v[28:31], v[48:51], v[44:47], v[28:31]
    ds_read_b64 v[80:81], v14 offset:3456
    v_mfma_f32_16x16x32_bf16 v[20:23], v[52:55], v[32:35], v[20:23]
    s_add_u32 m0, s91, 65536
    s_add_u32 s56, s89, 0
    buffer_load_dwordx4 v244, s[92:95], s56 offen lds
    ds_read_b64 v[82:83], v14 offset:3464
    v_mfma_f32_16x16x32_bf16 v[24:27], v[52:55], v[36:39], v[24:27]
    ds_read_b64 v[84:85], v14 offset:2432
    v_mfma_f32_16x16x32_bf16 v[28:31], v[52:55], v[40:43], v[28:31]
    ds_read_b64 v[86:87], v14 offset:2440
    v_mfma_f32_16x16x32_bf16 v[24:27], v[56:59], v[32:35], v[24:27]
    ds_read_b64 v[88:89], v14 offset:1408
    v_mfma_f32_16x16x32_bf16 v[28:31], v[56:59], v[36:39], v[28:31]
    ds_read_b64 v[90:91], v14 offset:1416
    v_mfma_f32_16x16x32_bf16 v[28:31], v[60:63], v[32:35], v[28:31]
    ds_read_b64 v[92:93], v14 offset:384
    ds_read_b64 v[94:95], v14 offset:392
    s_add_u32 m0, s91, 66560
    s_add_u32 s56, s89, 0
    buffer_load_dwordx4 v245, s[92:95], s56 offen lds
    s_waitcnt lgkmcnt(0)
    ds_read_b128 v[32:35], v15 offset:320
    v_mfma_f32_16x16x32_bf16 v[16:19], v[80:83], v[64:67], v[16:19]
    ds_read_b128 v[36:39], v15 offset:1344
    v_mfma_f32_16x16x32_bf16 v[20:23], v[80:83], v[68:71], v[20:23]
    ds_read_b128 v[40:43], v15 offset:2368
    v_mfma_f32_16x16x32_bf16 v[24:27], v[80:83], v[72:75], v[24:27]
    ds_read_b128 v[44:47], v15 offset:3392
    v_mfma_f32_16x16x32_bf16 v[28:31], v[80:83], v[76:79], v[28:31]
    ds_read_b64 v[48:49], v14 offset:3392
    v_mfma_f32_16x16x32_bf16 v[20:23], v[84:87], v[64:67], v[20:23]
    s_add_u32 m0, s91, 67584
    s_add_u32 s56, s89, 0
    buffer_load_dwordx4 v246, s[92:95], s56 offen lds
    ds_read_b64 v[50:51], v14 offset:3400
    v_mfma_f32_16x16x32_bf16 v[24:27], v[84:87], v[68:71], v[24:27]
    ds_read_b64 v[52:53], v14 offset:2368
    v_mfma_f32_16x16x32_bf16 v[28:31], v[84:87], v[72:75], v[28:31]
    ds_read_b64 v[54:55], v14 offset:2376
    v_mfma_f32_16x16x32_bf16 v[24:27], v[88:91], v[64:67], v[24:27]
    ds_read_b64 v[56:57], v14 offset:1344
    v_mfma_f32_16x16x32_bf16 v[28:31], v[88:91], v[68:71], v[28:31]
    ds_read_b64 v[58:59], v14 offset:1352
    v_mfma_f32_16x16x32_bf16 v[28:31], v[92:95], v[64:67], v[28:31]
    ds_read_b64 v[60:61], v14 offset:320
    ds_read_b64 v[62:63], v14 offset:328
    s_add_u32 m0, s91, 90112
    s_add_u32 s56, s89, 176128
    buffer_load_dwordx4 v244, s[92:95], s56 offen lds
    s_waitcnt lgkmcnt(0)
    ds_read_b128 v[64:67], v15 offset:256
    v_mfma_f32_16x16x32_bf16 v[16:19], v[48:51], v[32:35], v[16:19]
    ds_read_b128 v[68:71], v15 offset:1280
    v_mfma_f32_16x16x32_bf16 v[20:23], v[48:51], v[36:39], v[20:23]
    ds_read_b128 v[72:75], v15 offset:2304
    v_mfma_f32_16x16x32_bf16 v[24:27], v[48:51], v[40:43], v[24:27]
    ds_read_b128 v[76:79], v15 offset:3328
    v_mfma_f32_16x16x32_bf16 v[28:31], v[48:51], v[44:47], v[28:31]
    ds_read_b64 v[80:81], v14 offset:3328
    v_mfma_f32_16x16x32_bf16 v[20:23], v[52:55], v[32:35], v[20:23]
    s_add_u32 m0, s91, 91136
    s_add_u32 s56, s89, 176128
    buffer_load_dwordx4 v245, s[92:95], s56 offen lds
    ds_read_b64 v[82:83], v14 offset:3336
    v_mfma_f32_16x16x32_bf16 v[24:27], v[52:55], v[36:39], v[24:27]
    ds_read_b64 v[84:85], v14 offset:2304
    v_mfma_f32_16x16x32_bf16 v[28:31], v[52:55], v[40:43], v[28:31]
    ds_read_b64 v[86:87], v14 offset:2312
    v_mfma_f32_16x16x32_bf16 v[24:27], v[56:59], v[32:35], v[24:27]
    ds_read_b64 v[88:89], v14 offset:1280
    v_mfma_f32_16x16x32_bf16 v[28:31], v[56:59], v[36:39], v[28:31]
    ds_read_b64 v[90:91], v14 offset:1288
    v_mfma_f32_16x16x32_bf16 v[28:31], v[60:63], v[32:35], v[28:31]
    ds_read_b64 v[92:93], v14 offset:256
    ds_read_b64 v[94:95], v14 offset:264
    s_add_u32 m0, s91, 92160
    s_add_u32 s56, s89, 176128
    buffer_load_dwordx4 v246, s[92:95], s56 offen lds
    s_waitcnt lgkmcnt(0)
    ds_read_b128 v[32:35], v15 offset:192
    v_mfma_f32_16x16x32_bf16 v[16:19], v[80:83], v[64:67], v[16:19]
    ds_read_b128 v[36:39], v15 offset:1216
    v_mfma_f32_16x16x32_bf16 v[20:23], v[80:83], v[68:71], v[20:23]
    ds_read_b128 v[40:43], v15 offset:2240
    v_mfma_f32_16x16x32_bf16 v[24:27], v[80:83], v[72:75], v[24:27]
    ds_read_b128 v[44:47], v15 offset:3264
    v_mfma_f32_16x16x32_bf16 v[28:31], v[80:83], v[76:79], v[28:31]
    ds_read_b64 v[48:49], v14 offset:3264
    v_mfma_f32_16x16x32_bf16 v[20:23], v[84:87], v[64:67], v[20:23]
    s_add_u32 m0, s91, 114688
    s_add_u32 s56, s89, 352256
    buffer_load_dwordx4 v244, s[92:95], s56 offen lds
    ds_read_b64 v[50:51], v14 offset:3272
    v_mfma_f32_16x16x32_bf16 v[24:27], v[84:87], v[68:71], v[24:27]
    ds_read_b64 v[52:53], v14 offset:2240
    v_mfma_f32_16x16x32_bf16 v[28:31], v[84:87], v[72:75], v[28:31]
    ds_read_b64 v[54:55], v14 offset:2248
    v_mfma_f32_16x16x32_bf16 v[24:27], v[88:91], v[64:67], v[24:27]
    ds_read_b64 v[56:57], v14 offset:1216
    v_mfma_f32_16x16x32_bf16 v[28:31], v[88:91], v[68:71], v[28:31]
    ds_read_b64 v[58:59], v14 offset:1224
    v_mfma_f32_16x16x32_bf16 v[28:31], v[92:95], v[64:67], v[28:31]
    ds_read_b64 v[60:61], v14 offset:192
    ds_read_b64 v[62:63], v14 offset:200
    s_add_u32 m0, s91, 115712
    s_add_u32 s56, s89, 352256
    buffer_load_dwordx4 v245, s[92:95], s56 offen lds
    s_waitcnt lgkmcnt(0)
    ds_read_b128 v[64:67], v15 offset:128
    v_mfma_f32_16x16x32_bf16 v[16:19], v[48:51], v[32:35], v[16:19]
    ds_read_b128 v[68:71], v15 offset:1152
    v_mfma_f32_16x16x32_bf16 v[20:23], v[48:51], v[36:39], v[20:23]
    ds_read_b128 v[72:75], v15 offset:2176
    v_mfma_f32_16x16x32_bf16 v[24:27], v[48:51], v[40:43], v[24:27]
    ds_read_b128 v[76:79], v15 offset:3200
    v_mfma_f32_16x16x32_bf16 v[28:31], v[48:51], v[44:47], v[28:31]
    ds_read_b64 v[80:81], v14 offset:3200
    v_mfma_f32_16x16x32_bf16 v[20:23], v[52:55], v[32:35], v[20:23]
    ds_read_b64 v[82:83], v14 offset:3208
    v_mfma_f32_16x16x32_bf16 v[24:27], v[52:55], v[36:39], v[24:27]
    ds_read_b64 v[84:85], v14 offset:2176
    v_mfma_f32_16x16x32_bf16 v[28:31], v[52:55], v[40:43], v[28:31]
    ds_read_b64 v[86:87], v14 offset:2184
    v_mfma_f32_16x16x32_bf16 v[24:27], v[56:59], v[32:35], v[24:27]
    ds_read_b64 v[88:89], v14 offset:1152
    v_mfma_f32_16x16x32_bf16 v[28:31], v[56:59], v[36:39], v[28:31]
    ds_read_b64 v[90:91], v14 offset:1160
    v_mfma_f32_16x16x32_bf16 v[28:31], v[60:63], v[32:35], v[28:31]
    ds_read_b64 v[92:93], v14 offset:128
    ds_read_b64 v[94:95], v14 offset:136
    s_add_u32 m0, s91, 116736
    s_add_u32 s56, s89, 352256
    buffer_load_dwordx4 v246, s[92:95], s56 offen lds
    s_waitcnt lgkmcnt(0)
    ds_read_b128 v[32:35], v15 offset:64
    v_mfma_f32_16x16x32_bf16 v[16:19], v[80:83], v[64:67], v[16:19]
    ds_read_b128 v[36:39], v15 offset:1088
    v_mfma_f32_16x16x32_bf16 v[20:23], v[80:83], v[68:71], v[20:23]
    ds_read_b128 v[40:43], v15 offset:2112
    v_mfma_f32_16x16x32_bf16 v[24:27], v[80:83], v[72:75], v[24:27]
    ds_read_b128 v[44:47], v15 offset:3136
    v_mfma_f32_16x16x32_bf16 v[28:31], v[80:83], v[76:79], v[28:31]
    ds_read_b64 v[48:49], v14 offset:3136
    v_mfma_f32_16x16x32_bf16 v[20:23], v[84:87], v[64:67], v[20:23]
    ds_read_b64 v[50:51], v14 offset:3144
    v_mfma_f32_16x16x32_bf16 v[24:27], v[84:87], v[68:71], v[24:27]
    ds_read_b64 v[52:53], v14 offset:2112
    v_mfma_f32_16x16x32_bf16 v[28:31], v[84:87], v[72:75], v[28:31]
    ds_read_b64 v[54:55], v14 offset:2120
    v_mfma_f32_16x16x32_bf16 v[24:27], v[88:91], v[64:67], v[24:27]
    ds_read_b64 v[56:57], v14 offset:1088
    v_mfma_f32_16x16x32_bf16 v[28:31], v[88:91], v[68:71], v[28:31]
    ds_read_b64 v[58:59], v14 offset:1096
    v_mfma_f32_16x16x32_bf16 v[28:31], v[92:95], v[64:67], v[28:31]
    ds_read_b64 v[60:61], v14 offset:64
    ds_read_b64 v[62:63], v14 offset:72
    s_add_u32 m0, s91, 139264
    s_add_u32 s56, s89, 528384
    buffer_load_dwordx4 v244, s[92:95], s56 offen lds
    s_waitcnt lgkmcnt(0)
    ds_read_b128 v[64:67], v15 offset:0
    v_mfma_f32_16x16x32_bf16 v[16:19], v[48:51], v[32:35], v[16:19]
    ds_read_b128 v[68:71], v15 offset:1024
    v_mfma_f32_16x16x32_bf16 v[20:23], v[48:51], v[36:39], v[20:23]
    ds_read_b128 v[72:75], v15 offset:2048
    v_mfma_f32_16x16x32_bf16 v[24:27], v[48:51], v[40:43], v[24:27]
    ds_read_b128 v[76:79], v15 offset:3072
    v_mfma_f32_16x16x32_bf16 v[28:31], v[48:51], v[44:47], v[28:31]
    ds_read_b64 v[80:81], v14 offset:3072
    v_mfma_f32_16x16x32_bf16 v[20:23], v[52:55], v[32:35], v[20:23]
    ds_read_b64 v[82:83], v14 offset:3080
    v_mfma_f32_16x16x32_bf16 v[24:27], v[52:55], v[36:39], v[24:27]
    ds_read_b64 v[84:85], v14 offset:2048
    v_mfma_f32_16x16x32_bf16 v[28:31], v[52:55], v[40:43], v[28:31]
    ds_read_b64 v[86:87], v14 offset:2056
    v_mfma_f32_16x16x32_bf16 v[24:27], v[56:59], v[32:35], v[24:27]
    ds_read_b64 v[88:89], v14 offset:1024
    v_mfma_f32_16x16x32_bf16 v[28:31], v[56:59], v[36:39], v[28:31]
    ds_read_b64 v[90:91], v14 offset:1032
    v_mfma_f32_16x16x32_bf16 v[28:31], v[60:63], v[32:35], v[28:31]
    ds_read_b64 v[92:93], v14 offset:0
    ds_read_b64 v[94:95], v14 offset:8
    s_add_u32 m0, s91, 140288
    s_add_u32 s56, s89, 528384
    buffer_load_dwordx4 v245, s[92:95], s56 offen lds
    s_waitcnt lgkmcnt(0)
    v_mfma_f32_16x16x32_bf16 v[16:19], v[80:83], v[64:67], v[16:19]
    v_mfma_f32_16x16x32_bf16 v[20:23], v[80:83], v[68:71], v[20:23]
    v_mfma_f32_16x16x32_bf16 v[24:27], v[80:83], v[72:75], v[24:27]
    v_mfma_f32_16x16x32_bf16 v[28:31], v[80:83], v[76:79], v[28:31]
    v_mfma_f32_16x16x32_bf16 v[20:23], v[84:87], v[64:67], v[20:23]
    v_mfma_f32_16x16x32_bf16 v[24:27], v[84:87], v[68:71], v[24:27]
    v_mfma_f32_16x16x32_bf16 v[28:31], v[84:87], v[72:75], v[28:31]
    v_mfma_f32_16x16x32_bf16 v[24:27], v[88:91], v[64:67], v[24:27]
    v_mfma_f32_16x16x32_bf16 v[28:31], v[88:91], v[68:71], v[28:31]
    v_mfma_f32_16x16x32_bf16 v[28:31], v[92:95], v[64:67], v[28:31]
    s_add_u32 m0, s91, 141312
    s_add_u32 s56, s89, 528384
    buffer_load_dwordx4 v246, s[92:95], s56 offen lds
    s_and_b32 s52, s44, 3
    s_lshl_b32 s53, s52, 11
    s_add_u32 s53, s53, s75
    s_xor_b32 s52, s52, 1
    s_lshl_b32 s52, s52, 11
    s_add_u32 s52, s52, s75
    v_lshl_add_u32 v7, v1, 4, s53
    v_lshl_add_u32 v8, v1, 4, s52
    v_lshlrev_b32 v9, 6, v3
    v_lshl_add_u32 v9, v4, 3, v9
    s_lshl_b32 s52, s51, 11
    s_lshl_b32 s53, s50, 5
    s_add_u32 s52, s52, s53
    s_add_u32 s52, s52, s75
    v_add_u32 v9, s52, v9
    s_lshl_b32 s52, s74, 4
    s_lshr_b32 s77, s77, s52
    s_lshl_b32 s77, s77, 16
    s_barrier
    s_cmp_eq_u32 s51, 0
    s_cbranch_scc1 M_RW0
    ds_write_b128 v7, v[16:19]
    ds_write_b128 v7, v[20:23] offset:1024
    v_mov_b32 v16, v24
    v_mov_b32 v17, v25
    v_mov_b32 v18, v26
    v_mov_b32 v19, v27
    v_mov_b32 v20, v28
    v_mov_b32 v21, v29
    v_mov_b32 v22, v30
    v_mov_b32 v23, v31
    s_branch M_RJ
M_RW0:
    ds_write_b128 v7, v[24:27]
    ds_write_b128 v7, v[28:31] offset:1024
M_RJ:
    ds_read_b64 v[40:41], v9 offset:17664
    ds_read_b64 v[44:45], v9 offset:21760
    ds_read_b64 v[42:43], v9 offset:18688
    ds_read_b64 v[46:47], v9 offset:22784
    s_waitcnt lgkmcnt(0)
    s_barrier
    ds_read_b128 v[32:35], v8
    ds_read_b128 v[36:39], v8 offset:1024
    s_waitcnt lgkmcnt(0)
    v_add_f32 v16, v16, v32
    v_add_f32 v17, v17, v33
    v_add_f32 v18, v18, v34
    v_add_f32 v19, v19, v35
    v_add_f32 v20, v20, v36
    v_add_f32 v21, v21, v37
    v_add_f32 v22, v22, v38
    v_add_f32 v23, v23, v39
    v_cvt_pk_bf16_f32 v16, v16, v17
    v_lshlrev_b32 v50, 16, v40
    v_and_b32 v51, s60, v40
    v_mul_f32 v50, s77, v50
    v_mul_f32 v51, s77, v51
    v_cvt_pk_bf16_f32 v50, v50, v51
    v_and_b32 v17, s60, v16
    v_lshlrev_b32 v16, 16, v16
    v_and_b32 v51, s60, v50
    v_lshlrev_b32 v50, 16, v50
    v_add_f32 v16, v16, v50
    v_add_f32 v17, v17, v51
    v_cvt_pk_bf16_f32 v16, v16, v17
    v_lshlrev_b32 v50, 16, v44
    v_and_b32 v51, s60, v44
    v_and_b32 v17, s60, v16
    v_lshlrev_b32 v16, 16, v16
    v_add_f32 v16, v16, v50
    v_add_f32 v17, v17, v51
    v_cvt_pk_bf16_f32 v52, v16, v17
    v_cvt_pk_bf16_f32 v18, v18, v19
    v_lshlrev_b32 v50, 16, v41
    v_and_b32 v51, s60, v41
    v_mul_f32 v50, s77, v50
    v_mul_f32 v51, s77, v51
    v_cvt_pk_bf16_f32 v50, v50, v51
    v_and_b32 v19, s60, v18
    v_lshlrev_b32 v18, 16, v18
    v_and_b32 v51, s60, v50
    v_lshlrev_b32 v50, 16, v50
    v_add_f32 v18, v18, v50
    v_add_f32 v19, v19, v51
    v_cvt_pk_bf16_f32 v18, v18, v19
    v_lshlrev_b32 v50, 16, v45
    v_and_b32 v51, s60, v45
    v_and_b32 v19, s60, v18
    v_lshlrev_b32 v18, 16, v18
    v_add_f32 v18, v18, v50
    v_add_f32 v19, v19, v51
    v_cvt_pk_bf16_f32 v53, v18, v19
    ds_write_b64 v9, v[52:53] offset:21760
    v_cvt_pk_bf16_f32 v20, v20, v21
    v_lshlrev_b32 v50, 16, v42
    v_and_b32 v51, s60, v42
    v_mul_f32 v50, s77, v50
    v_mul_f32 v51, s77, v51
    v_cvt_pk_bf16_f32 v50, v50, v51
    v_and_b32 v21, s60, v20
    v_lshlrev_b32 v20, 16, v20
    v_and_b32 v51, s60, v50
    v_lshlrev_b32 v50, 16, v50
    v_add_f32 v20, v20, v50
    v_add_f32 v21, v21, v51
    v_cvt_pk_bf16_f32 v20, v20, v21
    v_lshlrev_b32 v50, 16, v46
    v_and_b32 v51, s60, v46
    v_and_b32 v21, s60, v20
    v_lshlrev_b32 v20, 16, v20
    v_add_f32 v20, v20, v50
    v_add_f32 v21, v21, v51
    v_cvt_pk_bf16_f32 v54, v20, v21
    v_cvt_pk_bf16_f32 v22, v22, v23
    v_lshlrev_b32 v50, 16, v43
    v_and_b32 v51, s60, v43
    v_mul_f32 v50, s77, v50
    v_mul_f32 v51, s77, v51
    v_cvt_pk_bf16_f32 v50, v50, v51
    v_and_b32 v23, s60, v22
    v_lshlrev_b32 v22, 16, v22
    v_and_b32 v51, s60, v50
    v_lshlrev_b32 v50, 16, v50
    v_add_f32 v22, v22, v50
    v_add_f32 v23, v23, v51
    v_cvt_pk_bf16_f32 v22, v22, v23
    v_lshlrev_b32 v50, 16, v47
    v_and_b32 v51, s60, v47
    v_and_b32 v23, s60, v22
    v_lshlrev_b32 v22, 16, v22
    v_add_f32 v22, v22, v50
    v_add_f32 v23, v23, v51
    v_cvt_pk_bf16_f32 v55, v22, v23
    ds_write_b64 v9, v[54:55] offset:22784
    v_and_b32 v5, 255, v0
    v_lshl_add_u32 v5, v5, 4, s75
    v_lshlrev_b32 v6, 4, v0
    s_lshl_b32 s52, s46, 13
    s_add_u32 s52, s52, 0x400000
    s_waitcnt lgkmcnt(0)
    s_barrier
    ds_read_b128 v[8:11], v5 offset:21760
    s_waitcnt lgkmcnt(0)
    buffer_store_dwordx4 v[8:11], v6, s[8:11], s52 offen sc1
    s_waitcnt vmcnt(0) lgkmcnt(0)
    s_barrier
    s_cmp_lg_u32 s44, 0
    s_cbranch_scc1 PUB_4
    s_mov_b64 exec, 0xff
    s_lshr_b32 s96, s46, 5
    s_lshl_b32 s96, s96, 10
    s_add_u32 s96, s96, 0xc10800
    v_lshl_add_u32 v252, v1, 7, s96
    v_mov_b32 v253, 1
    buffer_atomic_add v253, v252, s[8:11], 0 offen sc1
    s_mov_b64 exec, -1
PUB_4:
    s_mov_b32 s4, s36
    s_and_b32 s5, s37, 0xffff
    s_mov_b32 s6, 0x158000
    s_mov_b32 s7, 0x00020000
    s_lshr_b32 s52, s2, 3
    s_mul_i32 s52, s52, 43
    s_mul_i32 s53, s44, 6
    s_add_u32 s52, s52, s53
    s_sub_u32 s52, s52, 5
    s_lshl_b32 s52, s52, 10
    s_and_b32 s53, s73, 0x100
    s_lshl_b32 s53, s53, 1
    s_add_u32 s52, s52, s53
    v_lshrrev_b32 v5, 5, v1
    v_and_b32 v6, 31, v1
    v_lshlrev_b32 v6, 4, v6
    v_lshl_add_u32 v5, v5, 10, v6
    s_cmp_eq_u32 s44, 0
    s_cbranch_scc1 M_NOWARM
    buffer_load_dwordx4 v[172:175], v5, s[4:7], s52 offen
    buffer_load_dwordx4 v[176:179], v5, s[4:7], s52 offen offset:2048
    s_add_u32 s52, s52, 4096
    buffer_load_dwordx4 v[180:183], v5, s[4:7], s52 offen
M_NOWARM:
    s_cmp_lg_u32 s44, 0
    s_cbranch_scc1 POLLB_5
    s_and_b32 s96, s2, 7
    s_lshl_b32 s96, s96, 7
    s_add_u32 s96, s96, 0xc10800
    v_and_b32 v252, 3, v1
    v_lshl_add_u32 v252, v252, 10, s96
    s_mov_b32 s96, 32
    s_mov_b32 s97, 0
POLL_6:
    buffer_load_dword v253, v252, s[8:11], 0 offen sc1
    s_waitcnt vmcnt(0)
    v_cmp_ne_u32 vcc, s96, v253
    s_add_u32 s97, s97, 1
    s_nop 3
    s_cmp_eq_u64 vcc, 0
    s_cbranch_scc1 POLLE_7
    s_cmp_gt_u32 s97, 0x200000
    s_cbranch_scc1 POLLE_7
    s_sleep 1
    s_branch POLL_6
POLLE_7:
POLLB_5:
    s_barrier
    s_cmp_ge_u32 s44, 4
    s_cbranch_scc1 M_LOADER
    s_and_b32 s50, s44, 1
    s_lshr_b32 s51, s44, 1
    v_lshrrev_b32 v5, 2, v3
    v_and_b32 v6, 3, v3
    v_lshl_add_u32 v7, v4, 2, v5
    v_and_b32 v8, 7, v7
    s_lshl_b32 s52, s51, 1
    s_add_u32 s52, s52, 0
    s_and_b32 s52, s52, 3
    s_lshl_b32 s53, s50, 2
    s_add_u32 s52, s52, s53
    v_xor_b32 v9, s52, v8
    v_lshlrev_b32 v9, 5, v9
    v_lshl_add_u32 v9, v6, 3, v9
    v_lshl_add_u32 v10, v7, 8, v9
    s_lshl_b32 s52, s51, 1
    s_add_u32 s52, s52, 1
    s_and_b32 s52, s52, 3
    s_lshl_b32 s53, s50, 2
    s_add_u32 s52, s52, s53
    v_xor_b32 v9, s52, v8
    v_lshlrev_b32 v9, 5, v9
    v_lshl_add_u32 v9, v6, 3, v9
    v_lshl_add_u32 v11, v7, 8, v9
    s_lshl_b32 s52, s51, 1
    s_add_u32 s52, s52, 2
    s_and_b32 s52, s52, 3
    s_lshl_b32 s53, s50, 2
    s_add_u32 s52, s52, s53
    v_xor_b32 v9, s52, v8
    v_lshlrev_b32 v9, 5, v9
    v_lshl_add_u32 v9, v6, 3, v9
    v_lshl_add_u32 v12, v7, 8, v9
    s_lshl_b32 s52, s51, 1
    s_add_u32 s52, s52, 3
    s_and_b32 s52, s52, 3
    s_lshl_b32 s53, s50, 2
    s_add_u32 s52, s52, s53
    v_xor_b32 v9, s52, v8
    v_lshlrev_b32 v9, 5, v9
    v_lshl_add_u32 v9, v6, 3, v9
    v_lshl_add_u32 v13, v7, 8, v9
    v_and_b32 v8, 1, v4
    s_mul_i32 s52, s51, 3
    s_add_u32 s52, s52, 0
    v_xor_b32 v9, s52, v8
    v_lshlrev_b32 v9, 5, v9
    v_lshl_add_u32 v9, v6, 3, v9
    v_mul_u32_u24 v236, 192, v7
    v_add_u32 v236, v236, v9
    v_add_u32 v236, 0x10000, v236
    s_mul_i32 s52, s51, 3
    s_add_u32 s52, s52, 1
    v_xor_b32 v9, s52, v8
    v_lshlrev_b32 v9, 5, v9
    v_lshl_add_u32 v9, v6, 3, v9
    v_mul_u32_u24 v237, 192, v7
    v_add_u32 v237, v237, v9
    v_add_u32 v237, 0x10000, v237
    s_mul_i32 s52, s51, 3
    s_add_u32 s52, s52, 2
    v_xor_b32 v9, s52, v8
    v_lshlrev_b32 v9, 5, v9
    v_lshl_add_u32 v9, v6, 3, v9
    v_mul_u32_u24 v238, 192, v7
    v_add_u32 v238, v238, v9
    v_add_u32 v238, 0x10000, v238
    v_mov_b32 v16, 0
    v_mov_b32 v17, 0
    v_mov_b32 v18, 0
    v_mov_b32 v19, 0
    v_mov_b32 v20, 0
    v_mov_b32 v21, 0
    v_mov_b32 v22, 0
    v_mov_b32 v23, 0
    v_mov_b32 v24, 0
    v_mov_b32 v25, 0
    v_mov_b32 v26, 0
    v_mov_b32 v27, 0
    v_mov_b32 v28, 0
    v_mov_b32 v29, 0
    v_mov_b32 v30, 0
    v_mov_b32 v31, 0
    v_mov_b32 v32, 0
    v_mov_b32 v33, 0
    v_mov_b32 v34, 0
    v_mov_b32 v35, 0
    v_mov_b32 v36, 0
    v_mov_b32 v37, 0
    v_mov_b32 v38, 0
    v_mov_b32 v39, 0
    v_mov_b32 v40, 0
    v_mov_b32 v41, 0
    v_mov_b32 v42, 0
    v_mov_b32 v43, 0
    v_mov_b32 v44, 0
    v_mov_b32 v45, 0
    v_mov_b32 v46, 0
    v_mov_b32 v47, 0
    v_mov_b32 v48, 0
    v_mov_b32 v49, 0
    v_mov_b32 v50, 0
    v_mov_b32 v51, 0
    v_mov_b32 v52, 0
    v_mov_b32 v53, 0
    v_mov_b32 v54, 0
    v_mov_b32 v55, 0
    v_mov_b32 v56, 0
    v_mov_b32 v57, 0
    v_mov_b32 v58, 0
    v_mov_b32 v59, 0
    v_mov_b32 v60, 0
    v_mov_b32 v61, 0
    v_mov_b32 v62, 0
    v_mov_b32 v63, 0
    v_mov_b32 v64, 0
    v_mov_b32 v65, 0
    v_mov_b32 v66, 0
    v_mov_b32 v67, 0
    v_mov_b32 v68, 0
    v_mov_b32 v69, 0
    v_mov_b32 v70, 0
    v_mov_b32 v71, 0
    v_mov_b32 v72, 0
    v_mov_b32 v73, 0
    v_mov_b32 v74, 0
    v_mov_b32 v75, 0
    v_mov_b32 v76, 0
    v_mov_b32 v77, 0
    v_mov_b32 v78, 0
    v_mov_b32 v79, 0
    v_mov_b32 v80, 0
    v_mov_b32 v81, 0
    v_mov_b32 v82, 0
    v_mov_b32 v83, 0
    v_mov_b32 v84, 0
    v_mov_b32 v85, 0
    v_mov_b32 v86, 0
    v_mov_b32 v87, 0
    v_mov_b32 v88, 0
    v_mov_b32 v89, 0
    v_mov_b32 v90, 0
    v_mov_b32 v91, 0
    v_mov_b32 v92, 0
    v_mov_b32 v93, 0
    v_mov_b32 v94, 0
    v_mov_b32 v95, 0
    v_mov_b32 v96, 0
    v_mov_b32 v97, 0
    v_mov_b32 v98, 0
    v_mov_b32 v99, 0
    v_mov_b32 v100, 0
    v_mov_b32 v101, 0
    v_mov_b32 v102, 0
    v_mov_b32 v103, 0
    v_mov_b32 v104, 0
    v_mov_b32 v105, 0
    v_mov_b32 v106, 0
    v_mov_b32 v107, 0
    v_mov_b32 v108, 0
    v_mov_b32 v109, 0
    v_mov_b32 v110, 0
    v_mov_b32 v111, 0
    v_mov_b32 v112, 0
    v_mov_b32 v113, 0
    v_mov_b32 v114, 0
    v_mov_b32 v115, 0
    v_mov_b32 v116, 0
    v_mov_b32 v117, 0
    v_mov_b32 v118, 0
    v_mov_b32 v119, 0
    v_mov_b32 v120, 0
    v_mov_b32 v121, 0
    v_mov_b32 v122, 0
    v_mov_b32 v123, 0
    v_mov_b32 v124, 0
    v_mov_b32 v125, 0
    v_mov_b32 v126, 0
    v_mov_b32 v127, 0
    v_mov_b32 v128, 0x3f803f80
    v_mov_b32 v129, 0x3f803f80
    v_mov_b32 v130, 0x3f803f80
    v_mov_b32 v131, 0x3f803f80
    v_mov_b32 v240, 0
    v_mov_b32 v241, 0
    v_mov_b32 v242, 0
    v_mov_b32 v243, 0
    v_mov_b32 v244, 0
    v_mov_b32 v245, 0
    v_mov_b32 v246, 0
    v_mov_b32 v247, 0
    v_mov_b32 v248, 0
    v_mov_b32 v249, 0
    v_mov_b32 v250, 0
    v_mov_b32 v251, 0
    s_waitcnt vmcnt(0)
    s_barrier
    ds_read_b64_tr_b16 v[132:133], v10 offset:0
    ds_read_b64_tr_b16 v[134:135], v10 offset:4096
    ds_read_b64_tr_b16 v[136:137], v11 offset:0
    ds_read_b64_tr_b16 v[138:139], v11 offset:4096
    ds_read_b64_tr_b16 v[140:141], v12 offset:0
    ds_read_b64_tr_b16 v[142:143], v12 offset:4096
    ds_read_b64_tr_b16 v[144:145], v13 offset:0
    ds_read_b64_tr_b16 v[146:147], v13 offset:4096
    ds_read_b64_tr_b16 v[148:149], v236 offset:0
    ds_read_b64_tr_b16 v[150:151], v236 offset:3072
    ds_read_b64_tr_b16 v[152:153], v236 offset:12288
    ds_read_b64_tr_b16 v[154:155], v236 offset:15360
    ds_read_b64_tr_b16 v[156:157], v237 offset:0
    ds_read_b64_tr_b16 v[158:159], v237 offset:3072
    ds_read_b64_tr_b16 v[160:161], v237 offset:12288
    ds_read_b64_tr_b16 v[162:163], v237 offset:15360
    ds_read_b64_tr_b16 v[164:165], v238 offset:0
    ds_read_b64_tr_b16 v[166:167], v238 offset:3072
    ds_read_b64_tr_b16 v[168:169], v238 offset:12288
    ds_read_b64_tr_b16 v[170:171], v238 offset:15360
    s_waitcnt lgkmcnt(0)
    v_mfma_f32_16x16x32_bf16 v[16:19], v[148:151], v[132:135], v[16:19]
    ds_read_b64_tr_b16 v[172:173], v10 offset:8192
    v_mfma_f32_16x16x32_bf16 v[40:43], v[148:151], v[136:139], v[40:43]
    ds_read_b64_tr_b16 v[174:175], v10 offset:12288
    v_mfma_f32_16x16x32_bf16 v[64:67], v[148:151], v[140:143], v[64:67]
    ds_read_b64_tr_b16 v[176:177], v11 offset:8192
    v_mfma_f32_16x16x32_bf16 v[88:91], v[148:151], v[144:147], v[88:91]
    ds_read_b64_tr_b16 v[178:179], v11 offset:12288
    v_mfma_f32_16x16x32_bf16 v[20:23], v[152:155], v[132:135], v[20:23]
    ds_read_b64_tr_b16 v[180:181], v12 offset:8192
    v_mfma_f32_16x16x32_bf16 v[44:47], v[152:155], v[136:139], v[44:47]
    ds_read_b64_tr_b16 v[182:183], v12 offset:12288
    v_mfma_f32_16x16x32_bf16 v[68:71], v[152:155], v[140:143], v[68:71]
    ds_read_b64_tr_b16 v[184:185], v13 offset:8192
    v_mfma_f32_16x16x32_bf16 v[92:95], v[152:155], v[144:147], v[92:95]
    ds_read_b64_tr_b16 v[186:187], v13 offset:12288
    v_mfma_f32_16x16x32_bf16 v[24:27], v[156:159], v[132:135], v[24:27]
    ds_read_b64_tr_b16 v[188:189], v236 offset:6144
    v_mfma_f32_16x16x32_bf16 v[48:51], v[156:159], v[136:139], v[48:51]
    ds_read_b64_tr_b16 v[190:191], v236 offset:9216
    v_mfma_f32_16x16x32_bf16 v[72:75], v[156:159], v[140:143], v[72:75]
    ds_read_b64_tr_b16 v[192:193], v236 offset:18432
    v_mfma_f32_16x16x32_bf16 v[96:99], v[156:159], v[144:147], v[96:99]
    ds_read_b64_tr_b16 v[194:195], v236 offset:21504
    v_mfma_f32_16x16x32_bf16 v[28:31], v[160:163], v[132:135], v[28:31]
    ds_read_b64_tr_b16 v[196:197], v237 offset:6144
    v_mfma_f32_16x16x32_bf16 v[52:55], v[160:163], v[136:139], v[52:55]
    ds_read_b64_tr_b16 v[198:199], v237 offset:9216
    v_mfma_f32_16x16x32_bf16 v[76:79], v[160:163], v[140:143], v[76:79]
    ds_read_b64_tr_b16 v[200:201], v237 offset:18432
    v_mfma_f32_16x16x32_bf16 v[100:103], v[160:163], v[144:147], v[100:103]
    ds_read_b64_tr_b16 v[202:203], v237 offset:21504
    v_mfma_f32_16x16x32_bf16 v[32:35], v[164:167], v[132:135], v[32:35]
    ds_read_b64_tr_b16 v[204:205], v238 offset:6144
    v_mfma_f32_16x16x32_bf16 v[56:59], v[164:167], v[136:139], v[56:59]
    ds_read_b64_tr_b16 v[206:207], v238 offset:9216
    v_mfma_f32_16x16x32_bf16 v[80:83], v[164:167], v[140:143], v[80:83]
    ds_read_b64_tr_b16 v[208:209], v238 offset:18432
    v_mfma_f32_16x16x32_bf16 v[104:107], v[164:167], v[144:147], v[104:107]
    ds_read_b64_tr_b16 v[210:211], v238 offset:21504
    v_mfma_f32_16x16x32_bf16 v[36:39], v[168:171], v[132:135], v[36:39]
    v_mfma_f32_16x16x32_bf16 v[60:63], v[168:171], v[136:139], v[60:63]
    v_mfma_f32_16x16x32_bf16 v[84:87], v[168:171], v[140:143], v[84:87]
    v_mfma_f32_16x16x32_bf16 v[108:111], v[168:171], v[144:147], v[108:111]
    v_mfma_f32_16x16x32_bf16 v[112:115], v[132:135], v[132:135], v[112:115]
    v_mfma_f32_16x16x32_bf16 v[120:123], v[128:131], v[132:135], v[120:123]
    v_mfma_f32_16x16x32_bf16 v[116:119], v[136:139], v[136:139], v[116:119]
    v_mfma_f32_16x16x32_bf16 v[124:127], v[128:131], v[136:139], v[124:127]
    s_cmp_eq_u32 s50, 0
    s_cbranch_scc0 CS_8
    v_mfma_f32_16x16x32_bf16 v[240:243], v[148:151], v[128:131], v[240:243]
    v_mfma_f32_16x16x32_bf16 v[244:247], v[156:159], v[128:131], v[244:247]
    v_mfma_f32_16x16x32_bf16 v[248:251], v[164:167], v[128:131], v[248:251]
    s_branch CS_9
CS_8:
    v_mfma_f32_16x16x32_bf16 v[240:243], v[152:155], v[128:131], v[240:243]
    v_mfma_f32_16x16x32_bf16 v[244:247], v[160:163], v[128:131], v[244:247]
    v_mfma_f32_16x16x32_bf16 v[248:251], v[168:171], v[128:131], v[248:251]
CS_9:
    s_waitcnt lgkmcnt(0)
    s_barrier
    v_add_u32 v10, 16384, v10
    v_add_u32 v11, 16384, v11
    v_add_u32 v12, 16384, v12
    v_add_u32 v13, 16384, v13
    v_add_u32 v236, 24576, v236
    v_add_u32 v237, 24576, v237
    v_add_u32 v238, 24576, v238
    v_mfma_f32_16x16x32_bf16 v[16:19], v[188:191], v[172:175], v[16:19]
    ds_read_b64_tr_b16 v[132:133], v10 offset:0
    v_mfma_f32_16x16x32_bf16 v[40:43], v[188:191], v[176:179], v[40:43]
    ds_read_b64_tr_b16 v[134:135], v10 offset:4096
    v_mfma_f32_16x16x32_bf16 v[64:67], v[188:191], v[180:183], v[64:67]
    ds_read_b64_tr_b16 v[136:137], v11 offset:0
    v_mfma_f32_16x16x32_bf16 v[88:91], v[188:191], v[184:187], v[88:91]
    ds_read_b64_tr_b16 v[138:139], v11 offset:4096
    v_mfma_f32_16x16x32_bf16 v[20:23], v[192:195], v[172:175], v[20:23]
    ds_read_b64_tr_b16 v[140:141], v12 offset:0
    v_mfma_f32_16x16x32_bf16 v[44:47], v[192:195], v[176:179], v[44:47]
    ds_read_b64_tr_b16 v[142:143], v12 offset:4096
    v_mfma_f32_16x16x32_bf16 v[68:71], v[192:195], v[180:183], v[68:71]
    ds_read_b64_tr_b16 v[144:145], v13 offset:0
    v_mfma_f32_16x16x32_bf16 v[92:95], v[192:195], v[184:187], v[92:95]
    ds_read_b64_tr_b16 v[146:147], v13 offset:4096
    v_mfma_f32_16x16x32_bf16 v[24:27], v[196:199], v[172:175], v[24:27]
    ds_read_b64_tr_b16 v[148:149], v236 offset:0
    v_mfma_f32_16x16x32_bf16 v[48:51], v[196:199], v[176:179], v[48:51]
    ds_read_b64_tr_b16 v[150:151], v236 offset:3072
    v_mfma_f32_16x16x32_bf16 v[72:75], v[196:199], v[180:183], v[72:75]
    ds_read_b64_tr_b16 v[152:153], v236 offset:12288
    v_mfma_f32_16x16x32_bf16 v[96:99], v[196:199], v[184:187], v[96:99]
    ds_read_b64_tr_b16 v[154:155], v236 offset:15360
    v_mfma_f32_16x16x32_bf16 v[28:31], v[200:203], v[172:175], v[28:31]
    ds_read_b64_tr_b16 v[156:157], v237 offset:0
    v_mfma_f32_16x16x32_bf16 v[52:55], v[200:203], v[176:179], v[52:55]
    ds_read_b64_tr_b16 v[158:159], v237 offset:3072
    v_mfma_f32_16x16x32_bf16 v[76:79], v[200:203], v[180:183], v[76:79]
    ds_read_b64_tr_b16 v[160:161], v237 offset:12288
    v_mfma_f32_16x16x32_bf16 v[100:103], v[200:203], v[184:187], v[100:103]
    ds_read_b64_tr_b16 v[162:163], v237 offset:15360
    v_mfma_f32_16x16x32_bf16 v[32:35], v[204:207], v[172:175], v[32:35]
    ds_read_b64_tr_b16 v[164:165], v238 offset:0
    v_mfma_f32_16x16x32_bf16 v[56:59], v[204:207], v[176:179], v[56:59]
    ds_read_b64_tr_b16 v[166:167], v238 offset:3072
    v_mfma_f32_16x16x32_bf16 v[80:83], v[204:207], v[180:183], v[80:83]
    ds_read_b64_tr_b16 v[168:169], v238 offset:12288
    v_mfma_f32_16x16x32_bf16 v[104:107], v[204:207], v[184:187], v[104:107]
    ds_read_b64_tr_b16 v[170:171], v238 offset:15360
    v_mfma_f32_16x16x32_bf16 v[36:39], v[208:211], v[172:175], v[36:39]
    v_mfma_f32_16x16x32_bf16 v[60:63], v[208:211], v[176:179], v[60:63]
    v_mfma_f32_16x16x32_bf16 v[84:87], v[208:211], v[180:183], v[84:87]
    v_mfma_f32_16x16x32_bf16 v[108:111], v[208:211], v[184:187], v[108:111]
    v_mfma_f32_16x16x32_bf16 v[112:115], v[172:175], v[172:175], v[112:115]
    v_mfma_f32_16x16x32_bf16 v[120:123], v[128:131], v[172:175], v[120:123]
    v_mfma_f32_16x16x32_bf16 v[116:119], v[176:179], v[176:179], v[116:119]
    v_mfma_f32_16x16x32_bf16 v[124:127], v[128:131], v[176:179], v[124:127]
    s_cmp_eq_u32 s50, 0
    s_cbranch_scc0 CS_10
    v_mfma_f32_16x16x32_bf16 v[240:243], v[188:191], v[128:131], v[240:243]
    v_mfma_f32_16x16x32_bf16 v[244:247], v[196:199], v[128:131], v[244:247]
    v_mfma_f32_16x16x32_bf16 v[248:251], v[204:207], v[128:131], v[248:251]
    s_branch CS_11
CS_10:
    v_mfma_f32_16x16x32_bf16 v[240:243], v[192:195], v[128:131], v[240:243]
    v_mfma_f32_16x16x32_bf16 v[244:247], v[200:203], v[128:131], v[244:247]
    v_mfma_f32_16x16x32_bf16 v[248:251], v[208:211], v[128:131], v[248:251]
CS_11:
    s_waitcnt lgkmcnt(0)
    v_mfma_f32_16x16x32_bf16 v[16:19], v[148:151], v[132:135], v[16:19]
    ds_read_b64_tr_b16 v[172:173], v10 offset:8192
    v_mfma_f32_16x16x32_bf16 v[40:43], v[148:151], v[136:139], v[40:43]
    ds_read_b64_tr_b16 v[174:175], v10 offset:12288
    v_mfma_f32_16x16x32_bf16 v[64:67], v[148:151], v[140:143], v[64:67]
    ds_read_b64_tr_b16 v[176:177], v11 offset:8192
    v_mfma_f32_16x16x32_bf16 v[88:91], v[148:151], v[144:147], v[88:91]
    ds_read_b64_tr_b16 v[178:179], v11 offset:12288
    v_mfma_f32_16x16x32_bf16 v[20:23], v[152:155], v[132:135], v[20:23]
    ds_read_b64_tr_b16 v[180:181], v12 offset:8192
    v_mfma_f32_16x16x32_bf16 v[44:47], v[152:155], v[136:139], v[44:47]
    ds_read_b64_tr_b16 v[182:183], v12 offset:12288
    v_mfma_f32_16x16x32_bf16 v[68:71], v[152:155], v[140:143], v[68:71]
    ds_read_b64_tr_b16 v[184:185], v13 offset:8192
    v_mfma_f32_16x16x32_bf16 v[92:95], v[152:155], v[144:147], v[92:95]
    ds_read_b64_tr_b16 v[186:187], v13 offset:12288
    v_mfma_f32_16x16x32_bf16 v[24:27], v[156:159], v[132:135], v[24:27]
    ds_read_b64_tr_b16 v[188:189], v236 offset:6144
    v_mfma_f32_16x16x32_bf16 v[48:51], v[156:159], v[136:139], v[48:51]
    ds_read_b64_tr_b16 v[190:191], v236 offset:9216
    v_mfma_f32_16x16x32_bf16 v[72:75], v[156:159], v[140:143], v[72:75]
    ds_read_b64_tr_b16 v[192:193], v236 offset:18432
    v_mfma_f32_16x16x32_bf16 v[96:99], v[156:159], v[144:147], v[96:99]
    ds_read_b64_tr_b16 v[194:195], v236 offset:21504
    v_mfma_f32_16x16x32_bf16 v[28:31], v[160:163], v[132:135], v[28:31]
    ds_read_b64_tr_b16 v[196:197], v237 offset:6144
    v_mfma_f32_16x16x32_bf16 v[52:55], v[160:163], v[136:139], v[52:55]
    ds_read_b64_tr_b16 v[198:199], v237 offset:9216
    v_mfma_f32_16x16x32_bf16 v[76:79], v[160:163], v[140:143], v[76:79]
    ds_read_b64_tr_b16 v[200:201], v237 offset:18432
    v_mfma_f32_16x16x32_bf16 v[100:103], v[160:163], v[144:147], v[100:103]
    ds_read_b64_tr_b16 v[202:203], v237 offset:21504
    v_mfma_f32_16x16x32_bf16 v[32:35], v[164:167], v[132:135], v[32:35]
    ds_read_b64_tr_b16 v[204:205], v238 offset:6144
    v_mfma_f32_16x16x32_bf16 v[56:59], v[164:167], v[136:139], v[56:59]
    ds_read_b64_tr_b16 v[206:207], v238 offset:9216
    v_mfma_f32_16x16x32_bf16 v[80:83], v[164:167], v[140:143], v[80:83]
    ds_read_b64_tr_b16 v[208:209], v238 offset:18432
    v_mfma_f32_16x16x32_bf16 v[104:107], v[164:167], v[144:147], v[104:107]
    ds_read_b64_tr_b16 v[210:211], v238 offset:21504
    v_mfma_f32_16x16x32_bf16 v[36:39], v[168:171], v[132:135], v[36:39]
    v_mfma_f32_16x16x32_bf16 v[60:63], v[168:171], v[136:139], v[60:63]
    v_mfma_f32_16x16x32_bf16 v[84:87], v[168:171], v[140:143], v[84:87]
    v_mfma_f32_16x16x32_bf16 v[108:111], v[168:171], v[144:147], v[108:111]
    v_mfma_f32_16x16x32_bf16 v[112:115], v[132:135], v[132:135], v[112:115]
    v_mfma_f32_16x16x32_bf16 v[120:123], v[128:131], v[132:135], v[120:123]
    v_mfma_f32_16x16x32_bf16 v[116:119], v[136:139], v[136:139], v[116:119]
    v_mfma_f32_16x16x32_bf16 v[124:127], v[128:131], v[136:139], v[124:127]
    s_cmp_eq_u32 s50, 0
    s_cbranch_scc0 CS_12
    v_mfma_f32_16x16x32_bf16 v[240:243], v[148:151], v[128:131], v[240:243]
    v_mfma_f32_16x16x32_bf16 v[244:247], v[156:159], v[128:131], v[244:247]
    v_mfma_f32_16x16x32_bf16 v[248:251], v[164:167], v[128:131], v[248:251]
    s_branch CS_13
CS_12:
    v_mfma_f32_16x16x32_bf16 v[240:243], v[152:155], v[128:131], v[240:243]
    v_mfma_f32_16x16x32_bf16 v[244:247], v[160:163], v[128:131], v[244:247]
    v_mfma_f32_16x16x32_bf16 v[248:251], v[168:171], v[128:131], v[248:251]
CS_13:
    s_waitcnt lgkmcnt(0)
    s_barrier
    v_add_u32 v10, 16384, v10
    v_add_u32 v11, 16384, v11
    v_add_u32 v12, 16384, v12
    v_add_u32 v13, 16384, v13
    v_add_u32 v236, 24576, v236
    v_add_u32 v237, 24576, v237
    v_add_u32 v238, 24576, v238
    v_mfma_f32_16x16x32_bf16 v[16:19], v[188:191], v[172:175], v[16:19]
    ds_read_b64_tr_b16 v[132:133], v10 offset:0
    v_mfma_f32_16x16x32_bf16 v[40:43], v[188:191], v[176:179], v[40:43]
    ds_read_b64_tr_b16 v[134:135], v10 offset:4096
    v_mfma_f32_16x16x32_bf16 v[64:67], v[188:191], v[180:183], v[64:67]
    ds_read_b64_tr_b16 v[136:137], v11 offset:0
    v_mfma_f32_16x16x32_bf16 v[88:91], v[188:191], v[184:187], v[88:91]
    ds_read_b64_tr_b16 v[138:139], v11 offset:4096
    v_mfma_f32_16x16x32_bf16 v[20:23], v[192:195], v[172:175], v[20:23]
    ds_read_b64_tr_b16 v[140:141], v12 offset:0
    v_mfma_f32_16x16x32_bf16 v[44:47], v[192:195], v[176:179], v[44:47]
    ds_read_b64_tr_b16 v[142:143], v12 offset:4096
    v_mfma_f32_16x16x32_bf16 v[68:71], v[192:195], v[180:183], v[68:71]
    ds_read_b64_tr_b16 v[144:145], v13 offset:0
    v_mfma_f32_16x16x32_bf16 v[92:95], v[192:195], v[184:187], v[92:95]
    ds_read_b64_tr_b16 v[146:147], v13 offset:4096
    v_mfma_f32_16x16x32_bf16 v[24:27], v[196:199], v[172:175], v[24:27]
    ds_read_b64_tr_b16 v[148:149], v236 offset:0
    v_mfma_f32_16x16x32_bf16 v[48:51], v[196:199], v[176:179], v[48:51]
    ds_read_b64_tr_b16 v[150:151], v236 offset:3072
    v_mfma_f32_16x16x32_bf16 v[72:75], v[196:199], v[180:183], v[72:75]
    ds_read_b64_tr_b16 v[152:153], v236 offset:12288
    v_mfma_f32_16x16x32_bf16 v[96:99], v[196:199], v[184:187], v[96:99]
    ds_read_b64_tr_b16 v[154:155], v236 offset:15360
    v_mfma_f32_16x16x32_bf16 v[28:31], v[200:203], v[172:175], v[28:31]
    ds_read_b64_tr_b16 v[156:157], v237 offset:0
    v_mfma_f32_16x16x32_bf16 v[52:55], v[200:203], v[176:179], v[52:55]
    ds_read_b64_tr_b16 v[158:159], v237 offset:3072
    v_mfma_f32_16x16x32_bf16 v[76:79], v[200:203], v[180:183], v[76:79]
    ds_read_b64_tr_b16 v[160:161], v237 offset:12288
    v_mfma_f32_16x16x32_bf16 v[100:103], v[200:203], v[184:187], v[100:103]
    ds_read_b64_tr_b16 v[162:163], v237 offset:15360
    v_mfma_f32_16x16x32_bf16 v[32:35], v[204:207], v[172:175], v[32:35]
    ds_read_b64_tr_b16 v[164:165], v238 offset:0
    v_mfma_f32_16x16x32_bf16 v[56:59], v[204:207], v[176:179], v[56:59]
    ds_read_b64_tr_b16 v[166:167], v238 offset:3072
    v_mfma_f32_16x16x32_bf16 v[80:83], v[204:207], v[180:183], v[80:83]
    ds_read_b64_tr_b16 v[168:169], v238 offset:12288
    v_mfma_f32_16x16x32_bf16 v[104:107], v[204:207], v[184:187], v[104:107]
    ds_read_b64_tr_b16 v[170:171], v238 offset:15360
    v_mfma_f32_16x16x32_bf16 v[36:39], v[208:211], v[172:175], v[36:39]
    v_mfma_f32_16x16x32_bf16 v[60:63], v[208:211], v[176:179], v[60:63]
    v_mfma_f32_16x16x32_bf16 v[84:87], v[208:211], v[180:183], v[84:87]
    v_mfma_f32_16x16x32_bf16 v[108:111], v[208:211], v[184:187], v[108:111]
    v_mfma_f32_16x16x32_bf16 v[112:115], v[172:175], v[172:175], v[112:115]
    v_mfma_f32_16x16x32_bf16 v[120:123], v[128:131], v[172:175], v[120:123]
    v_mfma_f32_16x16x32_bf16 v[116:119], v[176:179], v[176:179], v[116:119]
    v_mfma_f32_16x16x32_bf16 v[124:127], v[128:131], v[176:179], v[124:127]
    s_cmp_eq_u32 s50, 0
    s_cbranch_scc0 CS_14
    v_mfma_f32_16x16x32_bf16 v[240:243], v[188:191], v[128:131], v[240:243]
    v_mfma_f32_16x16x32_bf16 v[244:247], v[196:199], v[128:131], v[244:247]
    v_mfma_f32_16x16x32_bf16 v[248:251], v[204:207], v[128:131], v[248:251]
    s_branch CS_15
CS_14:
    v_mfma_f32_16x16x32_bf16 v[240:243], v[192:195], v[128:131], v[240:243]
    v_mfma_f32_16x16x32_bf16 v[244:247], v[200:203], v[128:131], v[244:247]
    v_mfma_f32_16x16x32_bf16 v[248:251], v[208:211], v[128:131], v[248:251]
CS_15:
    s_waitcnt lgkmcnt(0)
    v_mfma_f32_16x16x32_bf16 v[16:19], v[148:151], v[132:135], v[16:19]
    ds_read_b64_tr_b16 v[172:173], v10 offset:8192
    v_mfma_f32_16x16x32_bf16 v[40:43], v[148:151], v[136:139], v[40:43]
    ds_read_b64_tr_b16 v[174:175], v10 offset:12288
    v_mfma_f32_16x16x32_bf16 v[64:67], v[148:151], v[140:143], v[64:67]
    ds_read_b64_tr_b16 v[176:177], v11 offset:8192
    v_mfma_f32_16x16x32_bf16 v[88:91], v[148:151], v[144:147], v[88:91]
    ds_read_b64_tr_b16 v[178:179], v11 offset:12288
    v_mfma_f32_16x16x32_bf16 v[20:23], v[152:155], v[132:135], v[20:23]
    ds_read_b64_tr_b16 v[180:181], v12 offset:8192
    v_mfma_f32_16x16x32_bf16 v[44:47], v[152:155], v[136:139], v[44:47]
    ds_read_b64_tr_b16 v[182:183], v12 offset:12288
    v_mfma_f32_16x16x32_bf16 v[68:71], v[152:155], v[140:143], v[68:71]
    ds_read_b64_tr_b16 v[184:185], v13 offset:8192
    v_mfma_f32_16x16x32_bf16 v[92:95], v[152:155], v[144:147], v[92:95]
    ds_read_b64_tr_b16 v[186:187], v13 offset:12288
    v_mfma_f32_16x16x32_bf16 v[24:27], v[156:159], v[132:135], v[24:27]
    ds_read_b64_tr_b16 v[188:189], v236 offset:6144
    v_mfma_f32_16x16x32_bf16 v[48:51], v[156:159], v[136:139], v[48:51]
    ds_read_b64_tr_b16 v[190:191], v236 offset:9216
    v_mfma_f32_16x16x32_bf16 v[72:75], v[156:159], v[140:143], v[72:75]
    ds_read_b64_tr_b16 v[192:193], v236 offset:18432
    v_mfma_f32_16x16x32_bf16 v[96:99], v[156:159], v[144:147], v[96:99]
    ds_read_b64_tr_b16 v[194:195], v236 offset:21504
    v_mfma_f32_16x16x32_bf16 v[28:31], v[160:163], v[132:135], v[28:31]
    ds_read_b64_tr_b16 v[196:197], v237 offset:6144
    v_mfma_f32_16x16x32_bf16 v[52:55], v[160:163], v[136:139], v[52:55]
    ds_read_b64_tr_b16 v[198:199], v237 offset:9216
    v_mfma_f32_16x16x32_bf16 v[76:79], v[160:163], v[140:143], v[76:79]
    ds_read_b64_tr_b16 v[200:201], v237 offset:18432
    v_mfma_f32_16x16x32_bf16 v[100:103], v[160:163], v[144:147], v[100:103]
    ds_read_b64_tr_b16 v[202:203], v237 offset:21504
    v_mfma_f32_16x16x32_bf16 v[32:35], v[164:167], v[132:135], v[32:35]
    ds_read_b64_tr_b16 v[204:205], v238 offset:6144
    v_mfma_f32_16x16x32_bf16 v[56:59], v[164:167], v[136:139], v[56:59]
    ds_read_b64_tr_b16 v[206:207], v238 offset:9216
    v_mfma_f32_16x16x32_bf16 v[80:83], v[164:167], v[140:143], v[80:83]
    ds_read_b64_tr_b16 v[208:209], v238 offset:18432
    v_mfma_f32_16x16x32_bf16 v[104:107], v[164:167], v[144:147], v[104:107]
    ds_read_b64_tr_b16 v[210:211], v238 offset:21504
    v_mfma_f32_16x16x32_bf16 v[36:39], v[168:171], v[132:135], v[36:39]
    v_mfma_f32_16x16x32_bf16 v[60:63], v[168:171], v[136:139], v[60:63]
    v_mfma_f32_16x16x32_bf16 v[84:87], v[168:171], v[140:143], v[84:87]
    v_mfma_f32_16x16x32_bf16 v[108:111], v[168:171], v[144:147], v[108:111]
    v_mfma_f32_16x16x32_bf16 v[112:115], v[132:135], v[132:135], v[112:115]
    v_mfma_f32_16x16x32_bf16 v[120:123], v[128:131], v[132:135], v[120:123]
    v_mfma_f32_16x16x32_bf16 v[116:119], v[136:139], v[136:139], v[116:119]
    v_mfma_f32_16x16x32_bf16 v[124:127], v[128:131], v[136:139], v[124:127]
    s_cmp_eq_u32 s50, 0
    s_cbranch_scc0 CS_16
    v_mfma_f32_16x16x32_bf16 v[240:243], v[148:151], v[128:131], v[240:243]
    v_mfma_f32_16x16x32_bf16 v[244:247], v[156:159], v[128:131], v[244:247]
    v_mfma_f32_16x16x32_bf16 v[248:251], v[164:167], v[128:131], v[248:251]
    s_branch CS_17
CS_16:
    v_mfma_f32_16x16x32_bf16 v[240:243], v[152:155], v[128:131], v[240:243]
    v_mfma_f32_16x16x32_bf16 v[244:247], v[160:163], v[128:131], v[244:247]
    v_mfma_f32_16x16x32_bf16 v[248:251], v[168:171], v[128:131], v[248:251]
CS_17:
    s_waitcnt lgkmcnt(0)
    s_barrier
    v_add_u32 v10, 16384, v10
    v_add_u32 v11, 16384, v11
    v_add_u32 v12, 16384, v12
    v_add_u32 v13, 16384, v13
    v_add_u32 v236, 24576, v236
    v_add_u32 v237, 24576, v237
    v_add_u32 v238, 24576, v238
    v_mfma_f32_16x16x32_bf16 v[16:19], v[188:191], v[172:175], v[16:19]
    ds_read_b64_tr_b16 v[132:133], v10 offset:0
    v_mfma_f32_16x16x32_bf16 v[40:43], v[188:191], v[176:179], v[40:43]
    ds_read_b64_tr_b16 v[134:135], v10 offset:4096
    v_mfma_f32_16x16x32_bf16 v[64:67], v[188:191], v[180:183], v[64:67]
    ds_read_b64_tr_b16 v[136:137], v11 offset:0
    v_mfma_f32_16x16x32_bf16 v[88:91], v[188:191], v[184:187], v[88:91]
    ds_read_b64_tr_b16 v[138:139], v11 offset:4096
    v_mfma_f32_16x16x32_bf16 v[20:23], v[192:195], v[172:175], v[20:23]
    ds_read_b64_tr_b16 v[140:141], v12 offset:0
    v_mfma_f32_16x16x32_bf16 v[44:47], v[192:195], v[176:179], v[44:47]
    ds_read_b64_tr_b16 v[142:143], v12 offset:4096
    v_mfma_f32_16x16x32_bf16 v[68:71], v[192:195], v[180:183], v[68:71]
    ds_read_b64_tr_b16 v[144:145], v13 offset:0
    v_mfma_f32_16x16x32_bf16 v[92:95], v[192:195], v[184:187], v[92:95]
    ds_read_b64_tr_b16 v[146:147], v13 offset:4096
    v_mfma_f32_16x16x32_bf16 v[24:27], v[196:199], v[172:175], v[24:27]
    ds_read_b64_tr_b16 v[148:149], v236 offset:0
    v_mfma_f32_16x16x32_bf16 v[48:51], v[196:199], v[176:179], v[48:51]
    ds_read_b64_tr_b16 v[150:151], v236 offset:3072
    v_mfma_f32_16x16x32_bf16 v[72:75], v[196:199], v[180:183], v[72:75]
    ds_read_b64_tr_b16 v[152:153], v236 offset:12288
    v_mfma_f32_16x16x32_bf16 v[96:99], v[196:199], v[184:187], v[96:99]
    ds_read_b64_tr_b16 v[154:155], v236 offset:15360
    v_mfma_f32_16x16x32_bf16 v[28:31], v[200:203], v[172:175], v[28:31]
    ds_read_b64_tr_b16 v[156:157], v237 offset:0
    v_mfma_f32_16x16x32_bf16 v[52:55], v[200:203], v[176:179], v[52:55]
    ds_read_b64_tr_b16 v[158:159], v237 offset:3072
    v_mfma_f32_16x16x32_bf16 v[76:79], v[200:203], v[180:183], v[76:79]
    ds_read_b64_tr_b16 v[160:161], v237 offset:12288
    v_mfma_f32_16x16x32_bf16 v[100:103], v[200:203], v[184:187], v[100:103]
    ds_read_b64_tr_b16 v[162:163], v237 offset:15360
    v_mfma_f32_16x16x32_bf16 v[32:35], v[204:207], v[172:175], v[32:35]
    ds_read_b64_tr_b16 v[164:165], v238 offset:0
    v_mfma_f32_16x16x32_bf16 v[56:59], v[204:207], v[176:179], v[56:59]
    ds_read_b64_tr_b16 v[166:167], v238 offset:3072
    v_mfma_f32_16x16x32_bf16 v[80:83], v[204:207], v[180:183], v[80:83]
    ds_read_b64_tr_b16 v[168:169], v238 offset:12288
    v_mfma_f32_16x16x32_bf16 v[104:107], v[204:207], v[184:187], v[104:107]
    ds_read_b64_tr_b16 v[170:171], v238 offset:15360
    v_mfma_f32_16x16x32_bf16 v[36:39], v[208:211], v[172:175], v[36:39]
    v_mfma_f32_16x16x32_bf16 v[60:63], v[208:211], v[176:179], v[60:63]
    v_mfma_f32_16x16x32_bf16 v[84:87], v[208:211], v[180:183], v[84:87]
    v_mfma_f32_16x16x32_bf16 v[108:111], v[208:211], v[184:187], v[108:111]
    v_mfma_f32_16x16x32_bf16 v[112:115], v[172:175], v[172:175], v[112:115]
    v_mfma_f32_16x16x32_bf16 v[120:123], v[128:131], v[172:175], v[120:123]
    v_mfma_f32_16x16x32_bf16 v[116:119], v[176:179], v[176:179], v[116:119]
    v_mfma_f32_16x16x32_bf16 v[124:127], v[128:131], v[176:179], v[124:127]
    s_cmp_eq_u32 s50, 0
    s_cbranch_scc0 CS_18
    v_mfma_f32_16x16x32_bf16 v[240:243], v[188:191], v[128:131], v[240:243]
    v_mfma_f32_16x16x32_bf16 v[244:247], v[196:199], v[128:131], v[244:247]
    v_mfma_f32_16x16x32_bf16 v[248:251], v[204:207], v[128:131], v[248:251]
    s_branch CS_19
CS_18:
    v_mfma_f32_16x16x32_bf16 v[240:243], v[192:195], v[128:131], v[240:243]
    v_mfma_f32_16x16x32_bf16 v[244:247], v[200:203], v[128:131], v[244:247]
    v_mfma_f32_16x16x32_bf16 v[248:251], v[208:211], v[128:131], v[248:251]
CS_19:
    s_waitcnt lgkmcnt(0)
    v_mfma_f32_16x16x32_bf16 v[16:19], v[148:151], v[132:135], v[16:19]
    ds_read_b64_tr_b16 v[172:173], v10 offset:8192
    v_mfma_f32_16x16x32_bf16 v[40:43], v[148:151], v[136:139], v[40:43]
    ds_read_b64_tr_b16 v[174:175], v10 offset:12288
    v_mfma_f32_16x16x32_bf16 v[64:67], v[148:151], v[140:143], v[64:67]
    ds_read_b64_tr_b16 v[176:177], v11 offset:8192
    v_mfma_f32_16x16x32_bf16 v[88:91], v[148:151], v[144:147], v[88:91]
    ds_read_b64_tr_b16 v[178:179], v11 offset:12288
    v_mfma_f32_16x16x32_bf16 v[20:23], v[152:155], v[132:135], v[20:23]
    ds_read_b64_tr_b16 v[180:181], v12 offset:8192
    v_mfma_f32_16x16x32_bf16 v[44:47], v[152:155], v[136:139], v[44:47]
    ds_read_b64_tr_b16 v[182:183], v12 offset:12288
    v_mfma_f32_16x16x32_bf16 v[68:71], v[152:155], v[140:143], v[68:71]
    ds_read_b64_tr_b16 v[184:185], v13 offset:8192
    v_mfma_f32_16x16x32_bf16 v[92:95], v[152:155], v[144:147], v[92:95]
    ds_read_b64_tr_b16 v[186:187], v13 offset:12288
    v_mfma_f32_16x16x32_bf16 v[24:27], v[156:159], v[132:135], v[24:27]
    ds_read_b64_tr_b16 v[188:189], v236 offset:6144
    v_mfma_f32_16x16x32_bf16 v[48:51], v[156:159], v[136:139], v[48:51]
    ds_read_b64_tr_b16 v[190:191], v236 offset:9216
    v_mfma_f32_16x16x32_bf16 v[72:75], v[156:159], v[140:143], v[72:75]
    ds_read_b64_tr_b16 v[192:193], v236 offset:18432
    v_mfma_f32_16x16x32_bf16 v[96:99], v[156:159], v[144:147], v[96:99]
    ds_read_b64_tr_b16 v[194:195], v236 offset:21504
    v_mfma_f32_16x16x32_bf16 v[28:31], v[160:163], v[132:135], v[28:31]
    ds_read_b64_tr_b16 v[196:197], v237 offset:6144
    v_mfma_f32_16x16x32_bf16 v[52:55], v[160:163], v[136:139], v[52:55]
    ds_read_b64_tr_b16 v[198:199], v237 offset:9216
    v_mfma_f32_16x16x32_bf16 v[76:79], v[160:163], v[140:143], v[76:79]
    ds_read_b64_tr_b16 v[200:201], v237 offset:18432
    v_mfma_f32_16x16x32_bf16 v[100:103], v[160:163], v[144:147], v[100:103]
    ds_read_b64_tr_b16 v[202:203], v237 offset:21504
    v_mfma_f32_16x16x32_bf16 v[32:35], v[164:167], v[132:135], v[32:35]
    ds_read_b64_tr_b16 v[204:205], v238 offset:6144
    v_mfma_f32_16x16x32_bf16 v[56:59], v[164:167], v[136:139], v[56:59]
    ds_read_b64_tr_b16 v[206:207], v238 offset:9216
    v_mfma_f32_16x16x32_bf16 v[80:83], v[164:167], v[140:143], v[80:83]
    ds_read_b64_tr_b16 v[208:209], v238 offset:18432
    v_mfma_f32_16x16x32_bf16 v[104:107], v[164:167], v[144:147], v[104:107]
    ds_read_b64_tr_b16 v[210:211], v238 offset:21504
    v_mfma_f32_16x16x32_bf16 v[36:39], v[168:171], v[132:135], v[36:39]
    v_mfma_f32_16x16x32_bf16 v[60:63], v[168:171], v[136:139], v[60:63]
    v_mfma_f32_16x16x32_bf16 v[84:87], v[168:171], v[140:143], v[84:87]
    v_mfma_f32_16x16x32_bf16 v[108:111], v[168:171], v[144:147], v[108:111]
    v_mfma_f32_16x16x32_bf16 v[112:115], v[132:135], v[132:135], v[112:115]
    v_mfma_f32_16x16x32_bf16 v[120:123], v[128:131], v[132:135], v[120:123]
    v_mfma_f32_16x16x32_bf16 v[116:119], v[136:139], v[136:139], v[116:119]
    v_mfma_f32_16x16x32_bf16 v[124:127], v[128:131], v[136:139], v[124:127]
    s_cmp_eq_u32 s50, 0
    s_cbranch_scc0 CS_20
    v_mfma_f32_16x16x32_bf16 v[240:243], v[148:151], v[128:131], v[240:243]
    v_mfma_f32_16x16x32_bf16 v[244:247], v[156:159], v[128:131], v[244:247]
    v_mfma_f32_16x16x32_bf16 v[248:251], v[164:167], v[128:131], v[248:251]
    s_branch CS_21
CS_20:
    v_mfma_f32_16x16x32_bf16 v[240:243], v[152:155], v[128:131], v[240:243]
    v_mfma_f32_16x16x32_bf16 v[244:247], v[160:163], v[128:131], v[244:247]
    v_mfma_f32_16x16x32_bf16 v[248:251], v[168:171], v[128:131], v[248:251]
CS_21:
    s_waitcnt lgkmcnt(0)
    s_barrier
    v_subrev_u32 v10, 49152, v10
    v_subrev_u32 v11, 49152, v11
    v_subrev_u32 v12, 49152, v12
    v_subrev_u32 v13, 49152, v13
    v_subrev_u32 v236, 73728, v236
    v_subrev_u32 v237, 73728, v237
    v_subrev_u32 v238, 73728, v238
    v_mfma_f32_16x16x32_bf16 v[16:19], v[188:191], v[172:175], v[16:19]
    ds_read_b64_tr_b16 v[132:133], v10 offset:0
    v_mfma_f32_16x16x32_bf16 v[40:43], v[188:191], v[176:179], v[40:43]
    ds_read_b64_tr_b16 v[134:135], v10 offset:4096
    v_mfma_f32_16x16x32_bf16 v[64:67], v[188:191], v[180:183], v[64:67]
    ds_read_b64_tr_b16 v[136:137], v11 offset:0
    v_mfma_f32_16x16x32_bf16 v[88:91], v[188:191], v[184:187], v[88:91]
    ds_read_b64_tr_b16 v[138:139], v11 offset:4096
    v_mfma_f32_16x16x32_bf16 v[20:23], v[192:195], v[172:175], v[20:23]
    ds_read_b64_tr_b16 v[140:141], v12 offset:0
    v_mfma_f32_16x16x32_bf16 v[44:47], v[192:195], v[176:179], v[44:47]
    ds_read_b64_tr_b16 v[142:143], v12 offset:4096
    v_mfma_f32_16x16x32_bf16 v[68:71], v[192:195], v[180:183], v[68:71]
    ds_read_b64_tr_b16 v[144:145], v13 offset:0
    v_mfma_f32_16x16x32_bf16 v[92:95], v[192:195], v[184:187], v[92:95]
    ds_read_b64_tr_b16 v[146:147], v13 offset:4096
    v_mfma_f32_16x16x32_bf16 v[24:27], v[196:199], v[172:175], v[24:27]
    ds_read_b64_tr_b16 v[148:149], v236 offset:0
    v_mfma_f32_16x16x32_bf16 v[48:51], v[196:199], v[176:179], v[48:51]
    ds_read_b64_tr_b16 v[150:151], v236 offset:3072
    v_mfma_f32_16x16x32_bf16 v[72:75], v[196:199], v[180:183], v[72:75]
    ds_read_b64_tr_b16 v[152:153], v236 offset:12288
    v_mfma_f32_16x16x32_bf16 v[96:99], v[196:199], v[184:187], v[96:99]
    ds_read_b64_tr_b16 v[154:155], v236 offset:15360
    v_mfma_f32_16x16x32_bf16 v[28:31], v[200:203], v[172:175], v[28:31]
    ds_read_b64_tr_b16 v[156:157], v237 offset:0
    v_mfma_f32_16x16x32_bf16 v[52:55], v[200:203], v[176:179], v[52:55]
    ds_read_b64_tr_b16 v[158:159], v237 offset:3072
    v_mfma_f32_16x16x32_bf16 v[76:79], v[200:203], v[180:183], v[76:79]
    ds_read_b64_tr_b16 v[160:161], v237 offset:12288
    v_mfma_f32_16x16x32_bf16 v[100:103], v[200:203], v[184:187], v[100:103]
    ds_read_b64_tr_b16 v[162:163], v237 offset:15360
    v_mfma_f32_16x16x32_bf16 v[32:35], v[204:207], v[172:175], v[32:35]
    ds_read_b64_tr_b16 v[164:165], v238 offset:0
    v_mfma_f32_16x16x32_bf16 v[56:59], v[204:207], v[176:179], v[56:59]
    ds_read_b64_tr_b16 v[166:167], v238 offset:3072
    v_mfma_f32_16x16x32_bf16 v[80:83], v[204:207], v[180:183], v[80:83]
    ds_read_b64_tr_b16 v[168:169], v238 offset:12288
    v_mfma_f32_16x16x32_bf16 v[104:107], v[204:207], v[184:187], v[104:107]
    ds_read_b64_tr_b16 v[170:171], v238 offset:15360
    v_mfma_f32_16x16x32_bf16 v[36:39], v[208:211], v[172:175], v[36:39]
    v_mfma_f32_16x16x32_bf16 v[60:63], v[208:211], v[176:179], v[60:63]
    v_mfma_f32_16x16x32_bf16 v[84:87], v[208:211], v[180:183], v[84:87]
    v_mfma_f32_16x16x32_bf16 v[108:111], v[208:211], v[184:187], v[108:111]
    v_mfma_f32_16x16x32_bf16 v[112:115], v[172:175], v[172:175], v[112:115]
    v_mfma_f32_16x16x32_bf16 v[120:123], v[128:131], v[172:175], v[120:123]
    v_mfma_f32_16x16x32_bf16 v[116:119], v[176:179], v[176:179], v[116:119]
    v_mfma_f32_16x16x32_bf16 v[124:127], v[128:131], v[176:179], v[124:127]
    s_cmp_eq_u32 s50, 0
    s_cbranch_scc0 CS_22
    v_mfma_f32_16x16x32_bf16 v[240:243], v[188:191], v[128:131], v[240:243]
    v_mfma_f32_16x16x32_bf16 v[244:247], v[196:199], v[128:131], v[244:247]
    v_mfma_f32_16x16x32_bf16 v[248:251], v[204:207], v[128:131], v[248:251]
    s_branch CS_23
CS_22:
    v_mfma_f32_16x16x32_bf16 v[240:243], v[192:195], v[128:131], v[240:243]
    v_mfma_f32_16x16x32_bf16 v[244:247], v[200:203], v[128:131], v[244:247]
    v_mfma_f32_16x16x32_bf16 v[248:251], v[208:211], v[128:131], v[248:251]
CS_23:
    s_waitcnt lgkmcnt(0)
    v_mfma_f32_16x16x32_bf16 v[16:19], v[148:151], v[132:135], v[16:19]
    ds_read_b64_tr_b16 v[172:173], v10 offset:8192
    v_mfma_f32_16x16x32_bf16 v[40:43], v[148:151], v[136:139], v[40:43]
    ds_read_b64_tr_b16 v[174:175], v10 offset:12288
    v_mfma_f32_16x16x32_bf16 v[64:67], v[148:151], v[140:143], v[64:67]
    ds_read_b64_tr_b16 v[176:177], v11 offset:8192
    v_mfma_f32_16x16x32_bf16 v[88:91], v[148:151], v[144:147], v[88:91]
    ds_read_b64_tr_b16 v[178:179], v11 offset:12288
    v_mfma_f32_16x16x32_bf16 v[20:23], v[152:155], v[132:135], v[20:23]
    ds_read_b64_tr_b16 v[180:181], v12 offset:8192
    v_mfma_f32_16x16x32_bf16 v[44:47], v[152:155], v[136:139], v[44:47]
    ds_read_b64_tr_b16 v[182:183], v12 offset:12288
    v_mfma_f32_16x16x32_bf16 v[68:71], v[152:155], v[140:143], v[68:71]
    ds_read_b64_tr_b16 v[184:185], v13 offset:8192
    v_mfma_f32_16x16x32_bf16 v[92:95], v[152:155], v[144:147], v[92:95]
    ds_read_b64_tr_b16 v[186:187], v13 offset:12288
    v_mfma_f32_16x16x32_bf16 v[24:27], v[156:159], v[132:135], v[24:27]
    ds_read_b64_tr_b16 v[188:189], v236 offset:6144
    v_mfma_f32_16x16x32_bf16 v[48:51], v[156:159], v[136:139], v[48:51]
    ds_read_b64_tr_b16 v[190:191], v236 offset:9216
    v_mfma_f32_16x16x32_bf16 v[72:75], v[156:159], v[140:143], v[72:75]
    ds_read_b64_tr_b16 v[192:193], v236 offset:18432
    v_mfma_f32_16x16x32_bf16 v[96:99], v[156:159], v[144:147], v[96:99]
    ds_read_b64_tr_b16 v[194:195], v236 offset:21504
    v_mfma_f32_16x16x32_bf16 v[28:31], v[160:163], v[132:135], v[28:31]
    ds_read_b64_tr_b16 v[196:197], v237 offset:6144
    v_mfma_f32_16x16x32_bf16 v[52:55], v[160:163], v[136:139], v[52:55]
    ds_read_b64_tr_b16 v[198:199], v237 offset:9216
    v_mfma_f32_16x16x32_bf16 v[76:79], v[160:163], v[140:143], v[76:79]
    ds_read_b64_tr_b16 v[200:201], v237 offset:18432
    v_mfma_f32_16x16x32_bf16 v[100:103], v[160:163], v[144:147], v[100:103]
    ds_read_b64_tr_b16 v[202:203], v237 offset:21504
    v_mfma_f32_16x16x32_bf16 v[32:35], v[164:167], v[132:135], v[32:35]
    ds_read_b64_tr_b16 v[204:205], v238 offset:6144
    v_mfma_f32_16x16x32_bf16 v[56:59], v[164:167], v[136:139], v[56:59]
    ds_read_b64_tr_b16 v[206:207], v238 offset:9216
    v_mfma_f32_16x16x32_bf16 v[80:83], v[164:167], v[140:143], v[80:83]
    ds_read_b64_tr_b16 v[208:209], v238 offset:18432
    v_mfma_f32_16x16x32_bf16 v[104:107], v[164:167], v[144:147], v[104:107]
    ds_read_b64_tr_b16 v[210:211], v238 offset:21504
    v_mfma_f32_16x16x32_bf16 v[36:39], v[168:171], v[132:135], v[36:39]
    v_mfma_f32_16x16x32_bf16 v[60:63], v[168:171], v[136:139], v[60:63]
    v_mfma_f32_16x16x32_bf16 v[84:87], v[168:171], v[140:143], v[84:87]
    v_mfma_f32_16x16x32_bf16 v[108:111], v[168:171], v[144:147], v[108:111]
    v_mfma_f32_16x16x32_bf16 v[112:115], v[132:135], v[132:135], v[112:115]
    v_mfma_f32_16x16x32_bf16 v[120:123], v[128:131], v[132:135], v[120:123]
    v_mfma_f32_16x16x32_bf16 v[116:119], v[136:139], v[136:139], v[116:119]
    v_mfma_f32_16x16x32_bf16 v[124:127], v[128:131], v[136:139], v[124:127]
    s_cmp_eq_u32 s50, 0
    s_cbranch_scc0 CS_24
    v_mfma_f32_16x16x32_bf16 v[240:243], v[148:151], v[128:131], v[240:243]
    v_mfma_f32_16x16x32_bf16 v[244:247], v[156:159], v[128:131], v[244:247]
    v_mfma_f32_16x16x32_bf16 v[248:251], v[164:167], v[128:131], v[248:251]
    s_branch CS_25
CS_24:
    v_mfma_f32_16x16x32_bf16 v[240:243], v[152:155], v[128:131], v[240:243]
    v_mfma_f32_16x16x32_bf16 v[244:247], v[160:163], v[128:131], v[244:247]
    v_mfma_f32_16x16x32_bf16 v[248:251], v[168:171], v[128:131], v[248:251]
CS_25:
    s_waitcnt lgkmcnt(0)
    s_barrier
    v_add_u32 v10, 16384, v10
    v_add_u32 v11, 16384, v11
    v_add_u32 v12, 16384, v12
    v_add_u32 v13, 16384, v13
    v_add_u32 v236, 24576, v236
    v_add_u32 v237, 24576, v237
    v_add_u32 v238, 24576, v238
    v_mfma_f32_16x16x32_bf16 v[16:19], v[188:191], v[172:175], v[16:19]
    ds_read_b64_tr_b16 v[132:133], v10 offset:0
    v_mfma_f32_16x16x32_bf16 v[40:43], v[188:191], v[176:179], v[40:43]
    ds_read_b64_tr_b16 v[134:135], v10 offset:4096
    v_mfma_f32_16x16x32_bf16 v[64:67], v[188:191], v[180:183], v[64:67]
    ds_read_b64_tr_b16 v[136:137], v11 offset:0
    v_mfma_f32_16x16x32_bf16 v[88:91], v[188:191], v[184:187], v[88:91]
    ds_read_b64_tr_b16 v[138:139], v11 offset:4096
    v_mfma_f32_16x16x32_bf16 v[20:23], v[192:195], v[172:175], v[20:23]
    ds_read_b64_tr_b16 v[140:141], v12 offset:0
    v_mfma_f32_16x16x32_bf16 v[44:47], v[192:195], v[176:179], v[44:47]
    ds_read_b64_tr_b16 v[142:143], v12 offset:4096
    v_mfma_f32_16x16x32_bf16 v[68:71], v[192:195], v[180:183], v[68:71]
    ds_read_b64_tr_b16 v[144:145], v13 offset:0
    v_mfma_f32_16x16x32_bf16 v[92:95], v[192:195], v[184:187], v[92:95]
    ds_read_b64_tr_b16 v[146:147], v13 offset:4096
    v_mfma_f32_16x16x32_bf16 v[24:27], v[196:199], v[172:175], v[24:27]
    ds_read_b64_tr_b16 v[148:149], v236 offset:0
    v_mfma_f32_16x16x32_bf16 v[48:51], v[196:199], v[176:179], v[48:51]
    ds_read_b64_tr_b16 v[150:151], v236 offset:3072
    v_mfma_f32_16x16x32_bf16 v[72:75], v[196:199], v[180:183], v[72:75]
    ds_read_b64_tr_b16 v[152:153], v236 offset:12288
    v_mfma_f32_16x16x32_bf16 v[96:99], v[196:199], v[184:187], v[96:99]
    ds_read_b64_tr_b16 v[154:155], v236 offset:15360
    v_mfma_f32_16x16x32_bf16 v[28:31], v[200:203], v[172:175], v[28:31]
    ds_read_b64_tr_b16 v[156:157], v237 offset:0
    v_mfma_f32_16x16x32_bf16 v[52:55], v[200:203], v[176:179], v[52:55]
    ds_read_b64_tr_b16 v[158:159], v237 offset:3072
    v_mfma_f32_16x16x32_bf16 v[76:79], v[200:203], v[180:183], v[76:79]
    ds_read_b64_tr_b16 v[160:161], v237 offset:12288
    v_mfma_f32_16x16x32_bf16 v[100:103], v[200:203], v[184:187], v[100:103]
    ds_read_b64_tr_b16 v[162:163], v237 offset:15360
    v_mfma_f32_16x16x32_bf16 v[32:35], v[204:207], v[172:175], v[32:35]
    ds_read_b64_tr_b16 v[164:165], v238 offset:0
    v_mfma_f32_16x16x32_bf16 v[56:59], v[204:207], v[176:179], v[56:59]
    ds_read_b64_tr_b16 v[166:167], v238 offset:3072
    v_mfma_f32_16x16x32_bf16 v[80:83], v[204:207], v[180:183], v[80:83]
    ds_read_b64_tr_b16 v[168:169], v238 offset:12288
    v_mfma_f32_16x16x32_bf16 v[104:107], v[204:207], v[184:187], v[104:107]
    ds_read_b64_tr_b16 v[170:171], v238 offset:15360
    v_mfma_f32_16x16x32_bf16 v[36:39], v[208:211], v[172:175], v[36:39]
    v_mfma_f32_16x16x32_bf16 v[60:63], v[208:211], v[176:179], v[60:63]
    v_mfma_f32_16x16x32_bf16 v[84:87], v[208:211], v[180:183], v[84:87]
    v_mfma_f32_16x16x32_bf16 v[108:111], v[208:211], v[184:187], v[108:111]
    v_mfma_f32_16x16x32_bf16 v[112:115], v[172:175], v[172:175], v[112:115]
    v_mfma_f32_16x16x32_bf16 v[120:123], v[128:131], v[172:175], v[120:123]
    v_mfma_f32_16x16x32_bf16 v[116:119], v[176:179], v[176:179], v[116:119]
    v_mfma_f32_16x16x32_bf16 v[124:127], v[128:131], v[176:179], v[124:127]
    s_cmp_eq_u32 s50, 0
    s_cbranch_scc0 CS_26
    v_mfma_f32_16x16x32_bf16 v[240:243], v[188:191], v[128:131], v[240:243]
    v_mfma_f32_16x16x32_bf16 v[244:247], v[196:199], v[128:131], v[244:247]
    v_mfma_f32_16x16x32_bf16 v[248:251], v[204:207], v[128:131], v[248:251]
    s_branch CS_27
CS_26:
    v_mfma_f32_16x16x32_bf16 v[240:243], v[192:195], v[128:131], v[240:243]
    v_mfma_f32_16x16x32_bf16 v[244:247], v[200:203], v[128:131], v[244:247]
    v_mfma_f32_16x16x32_bf16 v[248:251], v[208:211], v[128:131], v[248:251]
CS_27:
    s_waitcnt lgkmcnt(0)
    v_mfma_f32_16x16x32_bf16 v[16:19], v[148:151], v[132:135], v[16:19]
    ds_read_b64_tr_b16 v[172:173], v10 offset:8192
    v_mfma_f32_16x16x32_bf16 v[40:43], v[148:151], v[136:139], v[40:43]
    ds_read_b64_tr_b16 v[174:175], v10 offset:12288
    v_mfma_f32_16x16x32_bf16 v[64:67], v[148:151], v[140:143], v[64:67]
    ds_read_b64_tr_b16 v[176:177], v11 offset:8192
    v_mfma_f32_16x16x32_bf16 v[88:91], v[148:151], v[144:147], v[88:91]
    ds_read_b64_tr_b16 v[178:179], v11 offset:12288
    v_mfma_f32_16x16x32_bf16 v[20:23], v[152:155], v[132:135], v[20:23]
    ds_read_b64_tr_b16 v[180:181], v12 offset:8192
    v_mfma_f32_16x16x32_bf16 v[44:47], v[152:155], v[136:139], v[44:47]
    ds_read_b64_tr_b16 v[182:183], v12 offset:12288
    v_mfma_f32_16x16x32_bf16 v[68:71], v[152:155], v[140:143], v[68:71]
    ds_read_b64_tr_b16 v[184:185], v13 offset:8192
    v_mfma_f32_16x16x32_bf16 v[92:95], v[152:155], v[144:147], v[92:95]
    ds_read_b64_tr_b16 v[186:187], v13 offset:12288
    v_mfma_f32_16x16x32_bf16 v[24:27], v[156:159], v[132:135], v[24:27]
    ds_read_b64_tr_b16 v[188:189], v236 offset:6144
    v_mfma_f32_16x16x32_bf16 v[48:51], v[156:159], v[136:139], v[48:51]
    ds_read_b64_tr_b16 v[190:191], v236 offset:9216
    v_mfma_f32_16x16x32_bf16 v[72:75], v[156:159], v[140:143], v[72:75]
    ds_read_b64_tr_b16 v[192:193], v236 offset:18432
    v_mfma_f32_16x16x32_bf16 v[96:99], v[156:159], v[144:147], v[96:99]
    ds_read_b64_tr_b16 v[194:195], v236 offset:21504
    v_mfma_f32_16x16x32_bf16 v[28:31], v[160:163], v[132:135], v[28:31]
    ds_read_b64_tr_b16 v[196:197], v237 offset:6144
    v_mfma_f32_16x16x32_bf16 v[52:55], v[160:163], v[136:139], v[52:55]
    ds_read_b64_tr_b16 v[198:199], v237 offset:9216
    v_mfma_f32_16x16x32_bf16 v[76:79], v[160:163], v[140:143], v[76:79]
    ds_read_b64_tr_b16 v[200:201], v237 offset:18432
    v_mfma_f32_16x16x32_bf16 v[100:103], v[160:163], v[144:147], v[100:103]
    ds_read_b64_tr_b16 v[202:203], v237 offset:21504
    v_mfma_f32_16x16x32_bf16 v[32:35], v[164:167], v[132:135], v[32:35]
    ds_read_b64_tr_b16 v[204:205], v238 offset:6144
    v_mfma_f32_16x16x32_bf16 v[56:59], v[164:167], v[136:139], v[56:59]
    ds_read_b64_tr_b16 v[206:207], v238 offset:9216
    v_mfma_f32_16x16x32_bf16 v[80:83], v[164:167], v[140:143], v[80:83]
    ds_read_b64_tr_b16 v[208:209], v238 offset:18432
    v_mfma_f32_16x16x32_bf16 v[104:107], v[164:167], v[144:147], v[104:107]
    ds_read_b64_tr_b16 v[210:211], v238 offset:21504
    v_mfma_f32_16x16x32_bf16 v[36:39], v[168:171], v[132:135], v[36:39]
    v_mfma_f32_16x16x32_bf16 v[60:63], v[168:171], v[136:139], v[60:63]
    v_mfma_f32_16x16x32_bf16 v[84:87], v[168:171], v[140:143], v[84:87]
    v_mfma_f32_16x16x32_bf16 v[108:111], v[168:171], v[144:147], v[108:111]
    v_mfma_f32_16x16x32_bf16 v[112:115], v[132:135], v[132:135], v[112:115]
    v_mfma_f32_16x16x32_bf16 v[120:123], v[128:131], v[132:135], v[120:123]
    v_mfma_f32_16x16x32_bf16 v[116:119], v[136:139], v[136:139], v[116:119]
    v_mfma_f32_16x16x32_bf16 v[124:127], v[128:131], v[136:139], v[124:127]
    s_cmp_eq_u32 s50, 0
    s_cbranch_scc0 CS_28
    v_mfma_f32_16x16x32_bf16 v[240:243], v[148:151], v[128:131], v[240:243]
    v_mfma_f32_16x16x32_bf16 v[244:247], v[156:159], v[128:131], v[244:247]
    v_mfma_f32_16x16x32_bf16 v[248:251], v[164:167], v[128:131], v[248:251]
    s_branch CS_29
CS_28:
    v_mfma_f32_16x16x32_bf16 v[240:243], v[152:155], v[128:131], v[240:243]
    v_mfma_f32_16x16x32_bf16 v[244:247], v[160:163], v[128:131], v[244:247]
    v_mfma_f32_16x16x32_bf16 v[248:251], v[168:171], v[128:131], v[248:251]
CS_29:
    s_waitcnt lgkmcnt(0)
    s_barrier
    v_add_u32 v10, 16384, v10
    v_add_u32 v11, 16384, v11
    v_add_u32 v12, 16384, v12
    v_add_u32 v13, 16384, v13
    v_add_u32 v236, 24576, v236
    v_add_u32 v237, 24576, v237
    v_add_u32 v238, 24576, v238
    v_mfma_f32_16x16x32_bf16 v[16:19], v[188:191], v[172:175], v[16:19]
    ds_read_b64_tr_b16 v[132:133], v10 offset:0
    v_mfma_f32_16x16x32_bf16 v[40:43], v[188:191], v[176:179], v[40:43]
    ds_read_b64_tr_b16 v[134:135], v10 offset:4096
    v_mfma_f32_16x16x32_bf16 v[64:67], v[188:191], v[180:183], v[64:67]
    ds_read_b64_tr_b16 v[136:137], v11 offset:0
    v_mfma_f32_16x16x32_bf16 v[88:91], v[188:191], v[184:187], v[88:91]
    ds_read_b64_tr_b16 v[138:139], v11 offset:4096
    v_mfma_f32_16x16x32_bf16 v[20:23], v[192:195], v[172:175], v[20:23]
    ds_read_b64_tr_b16 v[140:141], v12 offset:0
    v_mfma_f32_16x16x32_bf16 v[44:47], v[192:195], v[176:179], v[44:47]
    ds_read_b64_tr_b16 v[142:143], v12 offset:4096
    v_mfma_f32_16x16x32_bf16 v[68:71], v[192:195], v[180:183], v[68:71]
    ds_read_b64_tr_b16 v[144:145], v13 offset:0
    v_mfma_f32_16x16x32_bf16 v[92:95], v[192:195], v[184:187], v[92:95]
    ds_read_b64_tr_b16 v[146:147], v13 offset:4096
    v_mfma_f32_16x16x32_bf16 v[24:27], v[196:199], v[172:175], v[24:27]
    ds_read_b64_tr_b16 v[148:149], v236 offset:0
    v_mfma_f32_16x16x32_bf16 v[48:51], v[196:199], v[176:179], v[48:51]
    ds_read_b64_tr_b16 v[150:151], v236 offset:3072
    v_mfma_f32_16x16x32_bf16 v[72:75], v[196:199], v[180:183], v[72:75]
    ds_read_b64_tr_b16 v[152:153], v236 offset:12288
    v_mfma_f32_16x16x32_bf16 v[96:99], v[196:199], v[184:187], v[96:99]
    ds_read_b64_tr_b16 v[154:155], v236 offset:15360
    v_mfma_f32_16x16x32_bf16 v[28:31], v[200:203], v[172:175], v[28:31]
    ds_read_b64_tr_b16 v[156:157], v237 offset:0
    v_mfma_f32_16x16x32_bf16 v[52:55], v[200:203], v[176:179], v[52:55]
    ds_read_b64_tr_b16 v[158:159], v237 offset:3072
    v_mfma_f32_16x16x32_bf16 v[76:79], v[200:203], v[180:183], v[76:79]
    ds_read_b64_tr_b16 v[160:161], v237 offset:12288
    v_mfma_f32_16x16x32_bf16 v[100:103], v[200:203], v[184:187], v[100:103]
    ds_read_b64_tr_b16 v[162:163], v237 offset:15360
    v_mfma_f32_16x16x32_bf16 v[32:35], v[204:207], v[172:175], v[32:35]
    ds_read_b64_tr_b16 v[164:165], v238 offset:0
    v_mfma_f32_16x16x32_bf16 v[56:59], v[204:207], v[176:179], v[56:59]
    ds_read_b64_tr_b16 v[166:167], v238 offset:3072
    v_mfma_f32_16x16x32_bf16 v[80:83], v[204:207], v[180:183], v[80:83]
    ds_read_b64_tr_b16 v[168:169], v238 offset:12288
    v_mfma_f32_16x16x32_bf16 v[104:107], v[204:207], v[184:187], v[104:107]
    ds_read_b64_tr_b16 v[170:171], v238 offset:15360
    v_mfma_f32_16x16x32_bf16 v[36:39], v[208:211], v[172:175], v[36:39]
    v_mfma_f32_16x16x32_bf16 v[60:63], v[208:211], v[176:179], v[60:63]
    v_mfma_f32_16x16x32_bf16 v[84:87], v[208:211], v[180:183], v[84:87]
    v_mfma_f32_16x16x32_bf16 v[108:111], v[208:211], v[184:187], v[108:111]
    v_mfma_f32_16x16x32_bf16 v[112:115], v[172:175], v[172:175], v[112:115]
    v_mfma_f32_16x16x32_bf16 v[120:123], v[128:131], v[172:175], v[120:123]
    v_mfma_f32_16x16x32_bf16 v[116:119], v[176:179], v[176:179], v[116:119]
    v_mfma_f32_16x16x32_bf16 v[124:127], v[128:131], v[176:179], v[124:127]
    s_cmp_eq_u32 s50, 0
    s_cbranch_scc0 CS_30
    v_mfma_f32_16x16x32_bf16 v[240:243], v[188:191], v[128:131], v[240:243]
    v_mfma_f32_16x16x32_bf16 v[244:247], v[196:199], v[128:131], v[244:247]
    v_mfma_f32_16x16x32_bf16 v[248:251], v[204:207], v[128:131], v[248:251]
    s_branch CS_31
CS_30:
    v_mfma_f32_16x16x32_bf16 v[240:243], v[192:195], v[128:131], v[240:243]
    v_mfma_f32_16x16x32_bf16 v[244:247], v[200:203], v[128:131], v[244:247]
    v_mfma_f32_16x16x32_bf16 v[248:251], v[208:211], v[128:131], v[248:251]
CS_31:
    s_waitcnt lgkmcnt(0)
    v_mfma_f32_16x16x32_bf16 v[16:19], v[148:151], v[132:135], v[16:19]
    ds_read_b64_tr_b16 v[172:173], v10 offset:8192
    v_mfma_f32_16x16x32_bf16 v[40:43], v[148:151], v[136:139], v[40:43]
    ds_read_b64_tr_b16 v[174:175], v10 offset:12288
    v_mfma_f32_16x16x32_bf16 v[64:67], v[148:151], v[140:143], v[64:67]
    ds_read_b64_tr_b16 v[176:177], v11 offset:8192
    v_mfma_f32_16x16x32_bf16 v[88:91], v[148:151], v[144:147], v[88:91]
    ds_read_b64_tr_b16 v[178:179], v11 offset:12288
    v_mfma_f32_16x16x32_bf16 v[20:23], v[152:155], v[132:135], v[20:23]
    ds_read_b64_tr_b16 v[180:181], v12 offset:8192
    v_mfma_f32_16x16x32_bf16 v[44:47], v[152:155], v[136:139], v[44:47]
    ds_read_b64_tr_b16 v[182:183], v12 offset:12288
    v_mfma_f32_16x16x32_bf16 v[68:71], v[152:155], v[140:143], v[68:71]
    ds_read_b64_tr_b16 v[184:185], v13 offset:8192
    v_mfma_f32_16x16x32_bf16 v[92:95], v[152:155], v[144:147], v[92:95]
    ds_read_b64_tr_b16 v[186:187], v13 offset:12288
    v_mfma_f32_16x16x32_bf16 v[24:27], v[156:159], v[132:135], v[24:27]
    ds_read_b64_tr_b16 v[188:189], v236 offset:6144
    v_mfma_f32_16x16x32_bf16 v[48:51], v[156:159], v[136:139], v[48:51]
    ds_read_b64_tr_b16 v[190:191], v236 offset:9216
    v_mfma_f32_16x16x32_bf16 v[72:75], v[156:159], v[140:143], v[72:75]
    ds_read_b64_tr_b16 v[192:193], v236 offset:18432
    v_mfma_f32_16x16x32_bf16 v[96:99], v[156:159], v[144:147], v[96:99]
    ds_read_b64_tr_b16 v[194:195], v236 offset:21504
    v_mfma_f32_16x16x32_bf16 v[28:31], v[160:163], v[132:135], v[28:31]
    ds_read_b64_tr_b16 v[196:197], v237 offset:6144
    v_mfma_f32_16x16x32_bf16 v[52:55], v[160:163], v[136:139], v[52:55]
    ds_read_b64_tr_b16 v[198:199], v237 offset:9216
    v_mfma_f32_16x16x32_bf16 v[76:79], v[160:163], v[140:143], v[76:79]
    ds_read_b64_tr_b16 v[200:201], v237 offset:18432
    v_mfma_f32_16x16x32_bf16 v[100:103], v[160:163], v[144:147], v[100:103]
    ds_read_b64_tr_b16 v[202:203], v237 offset:21504
    v_mfma_f32_16x16x32_bf16 v[32:35], v[164:167], v[132:135], v[32:35]
    ds_read_b64_tr_b16 v[204:205], v238 offset:6144
    v_mfma_f32_16x16x32_bf16 v[56:59], v[164:167], v[136:139], v[56:59]
    ds_read_b64_tr_b16 v[206:207], v238 offset:9216
    v_mfma_f32_16x16x32_bf16 v[80:83], v[164:167], v[140:143], v[80:83]
    ds_read_b64_tr_b16 v[208:209], v238 offset:18432
    v_mfma_f32_16x16x32_bf16 v[104:107], v[164:167], v[144:147], v[104:107]
    ds_read_b64_tr_b16 v[210:211], v238 offset:21504
    v_mfma_f32_16x16x32_bf16 v[36:39], v[168:171], v[132:135], v[36:39]
    v_mfma_f32_16x16x32_bf16 v[60:63], v[168:171], v[136:139], v[60:63]
    v_mfma_f32_16x16x32_bf16 v[84:87], v[168:171], v[140:143], v[84:87]
    v_mfma_f32_16x16x32_bf16 v[108:111], v[168:171], v[144:147], v[108:111]
    v_mfma_f32_16x16x32_bf16 v[112:115], v[132:135], v[132:135], v[112:115]
    v_mfma_f32_16x16x32_bf16 v[120:123], v[128:131], v[132:135], v[120:123]
    v_mfma_f32_16x16x32_bf16 v[116:119], v[136:139], v[136:139], v[116:119]
    v_mfma_f32_16x16x32_bf16 v[124:127], v[128:131], v[136:139], v[124:127]
    s_cmp_eq_u32 s50, 0
    s_cbranch_scc0 CS_32
    v_mfma_f32_16x16x32_bf16 v[240:243], v[148:151], v[128:131], v[240:243]
    v_mfma_f32_16x16x32_bf16 v[244:247], v[156:159], v[128:131], v[244:247]
    v_mfma_f32_16x16x32_bf16 v[248:251], v[164:167], v[128:131], v[248:251]
    s_branch CS_33
CS_32:
    v_mfma_f32_16x16x32_bf16 v[240:243], v[152:155], v[128:131], v[240:243]
    v_mfma_f32_16x16x32_bf16 v[244:247], v[160:163], v[128:131], v[244:247]
    v_mfma_f32_16x16x32_bf16 v[248:251], v[168:171], v[128:131], v[248:251]
CS_33:
    s_waitcnt lgkmcnt(0)
    s_barrier
    v_add_u32 v10, 16384, v10
    v_add_u32 v11, 16384, v11
    v_add_u32 v12, 16384, v12
    v_add_u32 v13, 16384, v13
    v_add_u32 v236, 24576, v236
    v_add_u32 v237, 24576, v237
    v_add_u32 v238, 24576, v238
    v_mfma_f32_16x16x32_bf16 v[16:19], v[188:191], v[172:175], v[16:19]
    ds_read_b64_tr_b16 v[132:133], v10 offset:0
    v_mfma_f32_16x16x32_bf16 v[40:43], v[188:191], v[176:179], v[40:43]
    ds_read_b64_tr_b16 v[134:135], v10 offset:4096
    v_mfma_f32_16x16x32_bf16 v[64:67], v[188:191], v[180:183], v[64:67]
    ds_read_b64_tr_b16 v[136:137], v11 offset:0
    v_mfma_f32_16x16x32_bf16 v[88:91], v[188:191], v[184:187], v[88:91]
    ds_read_b64_tr_b16 v[138:139], v11 offset:4096
    v_mfma_f32_16x16x32_bf16 v[20:23], v[192:195], v[172:175], v[20:23]
    ds_read_b64_tr_b16 v[140:141], v12 offset:0
    v_mfma_f32_16x16x32_bf16 v[44:47], v[192:195], v[176:179], v[44:47]
    ds_read_b64_tr_b16 v[142:143], v12 offset:4096
    v_mfma_f32_16x16x32_bf16 v[68:71], v[192:195], v[180:183], v[68:71]
    ds_read_b64_tr_b16 v[144:145], v13 offset:0
    v_mfma_f32_16x16x32_bf16 v[92:95], v[192:195], v[184:187], v[92:95]
    ds_read_b64_tr_b16 v[146:147], v13 offset:4096
    v_mfma_f32_16x16x32_bf16 v[24:27], v[196:199], v[172:175], v[24:27]
    ds_read_b64_tr_b16 v[148:149], v236 offset:0
    v_mfma_f32_16x16x32_bf16 v[48:51], v[196:199], v[176:179], v[48:51]
    ds_read_b64_tr_b16 v[150:151], v236 offset:3072
    v_mfma_f32_16x16x32_bf16 v[72:75], v[196:199], v[180:183], v[72:75]
    ds_read_b64_tr_b16 v[152:153], v236 offset:12288
    v_mfma_f32_16x16x32_bf16 v[96:99], v[196:199], v[184:187], v[96:99]
    ds_read_b64_tr_b16 v[154:155], v236 offset:15360
    v_mfma_f32_16x16x32_bf16 v[28:31], v[200:203], v[172:175], v[28:31]
    ds_read_b64_tr_b16 v[156:157], v237 offset:0
    v_mfma_f32_16x16x32_bf16 v[52:55], v[200:203], v[176:179], v[52:55]
    ds_read_b64_tr_b16 v[158:159], v237 offset:3072
    v_mfma_f32_16x16x32_bf16 v[76:79], v[200:203], v[180:183], v[76:79]
    ds_read_b64_tr_b16 v[160:161], v237 offset:12288
    v_mfma_f32_16x16x32_bf16 v[100:103], v[200:203], v[184:187], v[100:103]
    ds_read_b64_tr_b16 v[162:163], v237 offset:15360
    v_mfma_f32_16x16x32_bf16 v[32:35], v[204:207], v[172:175], v[32:35]
    ds_read_b64_tr_b16 v[164:165], v238 offset:0
    v_mfma_f32_16x16x32_bf16 v[56:59], v[204:207], v[176:179], v[56:59]
    ds_read_b64_tr_b16 v[166:167], v238 offset:3072
    v_mfma_f32_16x16x32_bf16 v[80:83], v[204:207], v[180:183], v[80:83]
    ds_read_b64_tr_b16 v[168:169], v238 offset:12288
    v_mfma_f32_16x16x32_bf16 v[104:107], v[204:207], v[184:187], v[104:107]
    ds_read_b64_tr_b16 v[170:171], v238 offset:15360
    v_mfma_f32_16x16x32_bf16 v[36:39], v[208:211], v[172:175], v[36:39]
    v_mfma_f32_16x16x32_bf16 v[60:63], v[208:211], v[176:179], v[60:63]
    v_mfma_f32_16x16x32_bf16 v[84:87], v[208:211], v[180:183], v[84:87]
    v_mfma_f32_16x16x32_bf16 v[108:111], v[208:211], v[184:187], v[108:111]
    v_mfma_f32_16x16x32_bf16 v[112:115], v[172:175], v[172:175], v[112:115]
    v_mfma_f32_16x16x32_bf16 v[120:123], v[128:131], v[172:175], v[120:123]
    v_mfma_f32_16x16x32_bf16 v[116:119], v[176:179], v[176:179], v[116:119]
    v_mfma_f32_16x16x32_bf16 v[124:127], v[128:131], v[176:179], v[124:127]
    s_cmp_eq_u32 s50, 0
    s_cbranch_scc0 CS_34
    v_mfma_f32_16x16x32_bf16 v[240:243], v[188:191], v[128:131], v[240:243]
    v_mfma_f32_16x16x32_bf16 v[244:247], v[196:199], v[128:131], v[244:247]
    v_mfma_f32_16x16x32_bf16 v[248:251], v[204:207], v[128:131], v[248:251]
    s_branch CS_35
CS_34:
    v_mfma_f32_16x16x32_bf16 v[240:243], v[192:195], v[128:131], v[240:243]
    v_mfma_f32_16x16x32_bf16 v[244:247], v[200:203], v[128:131], v[244:247]
    v_mfma_f32_16x16x32_bf16 v[248:251], v[208:211], v[128:131], v[248:251]
CS_35:
    s_waitcnt lgkmcnt(0)
    v_mfma_f32_16x16x32_bf16 v[16:19], v[148:151], v[132:135], v[16:19]
    ds_read_b64_tr_b16 v[172:173], v10 offset:8192
    v_mfma_f32_16x16x32_bf16 v[40:43], v[148:151], v[136:139], v[40:43]
    ds_read_b64_tr_b16 v[174:175], v10 offset:12288
    v_mfma_f32_16x16x32_bf16 v[64:67], v[148:151], v[140:143], v[64:67]
    ds_read_b64_tr_b16 v[176:177], v11 offset:8192
    v_mfma_f32_16x16x32_bf16 v[88:91], v[148:151], v[144:147], v[88:91]
    ds_read_b64_tr_b16 v[178:179], v11 offset:12288
    v_mfma_f32_16x16x32_bf16 v[20:23], v[152:155], v[132:135], v[20:23]
    ds_read_b64_tr_b16 v[180:181], v12 offset:8192
    v_mfma_f32_16x16x32_bf16 v[44:47], v[152:155], v[136:139], v[44:47]
    ds_read_b64_tr_b16 v[182:183], v12 offset:12288
    v_mfma_f32_16x16x32_bf16 v[68:71], v[152:155], v[140:143], v[68:71]
    ds_read_b64_tr_b16 v[184:185], v13 offset:8192
    v_mfma_f32_16x16x32_bf16 v[92:95], v[152:155], v[144:147], v[92:95]
    ds_read_b64_tr_b16 v[186:187], v13 offset:12288
    v_mfma_f32_16x16x32_bf16 v[24:27], v[156:159], v[132:135], v[24:27]
    ds_read_b64_tr_b16 v[188:189], v236 offset:6144
    v_mfma_f32_16x16x32_bf16 v[48:51], v[156:159], v[136:139], v[48:51]
    ds_read_b64_tr_b16 v[190:191], v236 offset:9216
    v_mfma_f32_16x16x32_bf16 v[72:75], v[156:159], v[140:143], v[72:75]
    ds_read_b64_tr_b16 v[192:193], v236 offset:18432
    v_mfma_f32_16x16x32_bf16 v[96:99], v[156:159], v[144:147], v[96:99]
    ds_read_b64_tr_b16 v[194:195], v236 offset:21504
    v_mfma_f32_16x16x32_bf16 v[28:31], v[160:163], v[132:135], v[28:31]
    ds_read_b64_tr_b16 v[196:197], v237 offset:6144
    v_mfma_f32_16x16x32_bf16 v[52:55], v[160:163], v[136:139], v[52:55]
    ds_read_b64_tr_b16 v[198:199], v237 offset:9216
    v_mfma_f32_16x16x32_bf16 v[76:79], v[160:163], v[140:143], v[76:79]
    ds_read_b64_tr_b16 v[200:201], v237 offset:18432
    v_mfma_f32_16x16x32_bf16 v[100:103], v[160:163], v[144:147], v[100:103]
    ds_read_b64_tr_b16 v[202:203], v237 offset:21504
    v_mfma_f32_16x16x32_bf16 v[32:35], v[164:167], v[132:135], v[32:35]
    ds_read_b64_tr_b16 v[204:205], v238 offset:6144
    v_mfma_f32_16x16x32_bf16 v[56:59], v[164:167], v[136:139], v[56:59]
    ds_read_b64_tr_b16 v[206:207], v238 offset:9216
    v_mfma_f32_16x16x32_bf16 v[80:83], v[164:167], v[140:143], v[80:83]
    ds_read_b64_tr_b16 v[208:209], v238 offset:18432
    v_mfma_f32_16x16x32_bf16 v[104:107], v[164:167], v[144:147], v[104:107]
    ds_read_b64_tr_b16 v[210:211], v238 offset:21504
    v_mfma_f32_16x16x32_bf16 v[36:39], v[168:171], v[132:135], v[36:39]
    v_mfma_f32_16x16x32_bf16 v[60:63], v[168:171], v[136:139], v[60:63]
    v_mfma_f32_16x16x32_bf16 v[84:87], v[168:171], v[140:143], v[84:87]
    v_mfma_f32_16x16x32_bf16 v[108:111], v[168:171], v[144:147], v[108:111]
    v_mfma_f32_16x16x32_bf16 v[112:115], v[132:135], v[132:135], v[112:115]
    v_mfma_f32_16x16x32_bf16 v[120:123], v[128:131], v[132:135], v[120:123]
    v_mfma_f32_16x16x32_bf16 v[116:119], v[136:139], v[136:139], v[116:119]
    v_mfma_f32_16x16x32_bf16 v[124:127], v[128:131], v[136:139], v[124:127]
    s_cmp_eq_u32 s50, 0
    s_cbranch_scc0 CS_36
    v_mfma_f32_16x16x32_bf16 v[240:243], v[148:151], v[128:131], v[240:243]
    v_mfma_f32_16x16x32_bf16 v[244:247], v[156:159], v[128:131], v[244:247]
    v_mfma_f32_16x16x32_bf16 v[248:251], v[164:167], v[128:131], v[248:251]
    s_branch CS_37
CS_36:
    v_mfma_f32_16x16x32_bf16 v[240:243], v[152:155], v[128:131], v[240:243]
    v_mfma_f32_16x16x32_bf16 v[244:247], v[160:163], v[128:131], v[244:247]
    v_mfma_f32_16x16x32_bf16 v[248:251], v[168:171], v[128:131], v[248:251]
CS_37:
    s_waitcnt lgkmcnt(0)
    v_mfma_f32_16x16x32_bf16 v[16:19], v[188:191], v[172:175], v[16:19]
    v_mfma_f32_16x16x32_bf16 v[40:43], v[188:191], v[176:179], v[40:43]
    v_mfma_f32_16x16x32_bf16 v[64:67], v[188:191], v[180:183], v[64:67]
    v_mfma_f32_16x16x32_bf16 v[88:91], v[188:191], v[184:187], v[88:91]
    v_mfma_f32_16x16x32_bf16 v[20:23], v[192:195], v[172:175], v[20:23]
    v_mfma_f32_16x16x32_bf16 v[44:47], v[192:195], v[176:179], v[44:47]
    v_mfma_f32_16x16x32_bf16 v[68:71], v[192:195], v[180:183], v[68:71]
    v_mfma_f32_16x16x32_bf16 v[92:95], v[192:195], v[184:187], v[92:95]
    v_mfma_f32_16x16x32_bf16 v[24:27], v[196:199], v[172:175], v[24:27]
    v_mfma_f32_16x16x32_bf16 v[48:51], v[196:199], v[176:179], v[48:51]
    v_mfma_f32_16x16x32_bf16 v[72:75], v[196:199], v[180:183], v[72:75]
    v_mfma_f32_16x16x32_bf16 v[96:99], v[196:199], v[184:187], v[96:99]
    v_mfma_f32_16x16x32_bf16 v[28:31], v[200:203], v[172:175], v[28:31]
    v_mfma_f32_16x16x32_bf16 v[52:55], v[200:203], v[176:179], v[52:55]
    v_mfma_f32_16x16x32_bf16 v[76:79], v[200:203], v[180:183], v[76:79]
    v_mfma_f32_16x16x32_bf16 v[100:103], v[200:203], v[184:187], v[100:103]
    v_mfma_f32_16x16x32_bf16 v[32:35], v[204:207], v[172:175], v[32:35]
    v_mfma_f32_16x16x32_bf16 v[56:59], v[204:207], v[176:179], v[56:59]
    v_mfma_f32_16x16x32_bf16 v[80:83], v[204:207], v[180:183], v[80:83]
    v_mfma_f32_16x16x32_bf16 v[104:107], v[204:207], v[184:187], v[104:107]
    v_mfma_f32_16x16x32_bf16 v[36:39], v[208:211], v[172:175], v[36:39]
    v_mfma_f32_16x16x32_bf16 v[60:63], v[208:211], v[176:179], v[60:63]
    v_mfma_f32_16x16x32_bf16 v[84:87], v[208:211], v[180:183], v[84:87]
    v_mfma_f32_16x16x32_bf16 v[108:111], v[208:211], v[184:187], v[108:111]
    v_mfma_f32_16x16x32_bf16 v[112:115], v[172:175], v[172:175], v[112:115]
    v_mfma_f32_16x16x32_bf16 v[120:123], v[128:131], v[172:175], v[120:123]
    v_mfma_f32_16x16x32_bf16 v[116:119], v[176:179], v[176:179], v[116:119]
    v_mfma_f32_16x16x32_bf16 v[124:127], v[128:131], v[176:179], v[124:127]
    s_cmp_eq_u32 s50, 0
    s_cbranch_scc0 CS_38
    v_mfma_f32_16x16x32_bf16 v[240:243], v[188:191], v[128:131], v[240:243]
    v_mfma_f32_16x16x32_bf16 v[244:247], v[196:199], v[128:131], v[244:247]
    v_mfma_f32_16x16x32_bf16 v[248:251], v[204:207], v[128:131], v[248:251]
    s_branch CS_39
CS_38:
    v_mfma_f32_16x16x32_bf16 v[240:243], v[192:195], v[128:131], v[240:243]
    v_mfma_f32_16x16x32_bf16 v[244:247], v[200:203], v[128:131], v[244:247]
    v_mfma_f32_16x16x32_bf16 v[248:251], v[208:211], v[128:131], v[248:251]
CS_39:
    s_lshl_b32 s52, s50, 6
    s_lshl_b32 s53, s51, 5
    s_add_u32 s52, s52, s53
    v_add_u32 v9, s52, v3
    v_lshlrev_b32 v9, 3, v9
    v_and_b32 v6, 3, v3
    v_lshrrev_b32 v5, 2, v3
    s_nop 7
    v_cmp_eq_u32 vcc, 1, v6
    s_nop 1
    v_cndmask_b32 v133, v112, v113, vcc
    v_cmp_eq_u32 vcc, 2, v6
    s_nop 1
    v_cndmask_b32 v133, v133, v114, vcc
    v_cmp_eq_u32 vcc, 3, v6
    s_nop 1
    v_cndmask_b32 v133, v133, v115, vcc
    v_mov_b32 v132, v120
    v_cmp_eq_u32 vcc, 1, v6
    s_nop 1
    v_cndmask_b32 v135, v116, v117, vcc
    v_cmp_eq_u32 vcc, 2, v6
    s_nop 1
    v_cndmask_b32 v135, v135, v118, vcc
    v_cmp_eq_u32 vcc, 3, v6
    s_nop 1
    v_cndmask_b32 v135, v135, v119, vcc
    v_mov_b32 v134, v124
    v_cmp_eq_u32 vcc, v4, v5
    s_and_saveexec_b64 s[54:55], vcc
    ds_write_b64 v9, v[132:133]
    ds_write_b64 v9, v[134:135] offset:128
    s_mov_b64 exec, s[54:55]
    s_mul_i32 s52, s50, 384
    s_mul_i32 s53, s51, 192
    s_add_u32 s52, s52, s53
    v_lshl_add_u32 v9, v4, 4, s52
    v_cmp_eq_u32 vcc, 0, v3
    s_and_saveexec_b64 s[54:55], vcc
    ds_write_b128 v9, v[240:243] offset:25600
    ds_write_b128 v9, v[244:247] offset:25664
    ds_write_b128 v9, v[248:251] offset:25728
    s_mov_b64 exec, s[54:55]
    s_lshl_b32 s52, s50, 6
    v_add_u32 v9, s52, v3
    v_mul_u32_u24 v8, 192, v9
    v_lshlrev_b32 v9, 3, v9
    s_waitcnt lgkmcnt(0)
    s_barrier
    s_lshl_b32 s52, s51, 1
    s_add_u32 s52, s52, 0
    s_and_b32 s52, s52, 3
    s_mul_i32 s56, s52, 3072
    s_lshl_b32 s52, s52, 7
    v_add_u32 v7, s52, v9
    ds_read_b64 v[132:133], v7
    s_lshl_b32 s52, s51, 1
    s_add_u32 s52, s52, 1
    s_and_b32 s52, s52, 3
    s_mul_i32 s57, s52, 3072
    s_lshl_b32 s52, s52, 7
    v_add_u32 v7, s52, v9
    ds_read_b64 v[134:135], v7
    s_lshl_b32 s52, s51, 1
    s_add_u32 s52, s52, 2
    s_and_b32 s52, s52, 3
    s_mul_i32 s58, s52, 3072
    s_lshl_b32 s52, s52, 7
    v_add_u32 v7, s52, v9
    ds_read_b64 v[136:137], v7
    s_lshl_b32 s52, s51, 1
    s_add_u32 s52, s52, 3
    s_and_b32 s52, s52, 3
    s_mul_i32 s59, s52, 3072
    s_lshl_b32 s52, s52, 7
    v_add_u32 v7, s52, v9
    ds_read_b64 v[138:139], v7
    s_mul_i32 s52, s51, 192
    v_lshl_add_u32 v7, v4, 4, s52
    ds_read_b128 v[212:215], v7 offset:25600
    ds_read_b128 v[216:219], v7 offset:25984
    ds_read_b128 v[220:223], v7 offset:25664
    ds_read_b128 v[224:227], v7 offset:26048
    ds_read_b128 v[228:231], v7 offset:25728
    ds_read_b128 v[232:235], v7 offset:26112
    v_lshrrev_b32 v5, 1, v4
    v_lshrrev_b32 v6, 3, v3
    v_lshl_add_u32 v5, v6, 1, v5
    s_mul_i32 s52, s51, 6
    v_add_u32 v5, s52, v5
    v_and_b32 v6, 1, v4
    v_lshl_add_u32 v8, v6, 3, v8
    v_add_u32 v8, 1024, v8
    v_add_u32 v6, 0, v5
    v_subrev_u32 v7, 12, v6
    v_cmp_le_u32 vcc, 12, v6
    s_nop 1
    v_cndmask_b32 v6, v6, v7, vcc
    v_lshl_add_u32 v164, v6, 4, v8
    v_add_u32 v6, 2, v5
    v_subrev_u32 v7, 12, v6
    v_cmp_le_u32 vcc, 12, v6
    s_nop 1
    v_cndmask_b32 v6, v6, v7, vcc
    v_lshl_add_u32 v165, v6, 4, v8
    v_add_u32 v6, 4, v5
    v_subrev_u32 v7, 12, v6
    v_cmp_le_u32 vcc, 12, v6
    s_nop 1
    v_cndmask_b32 v6, v6, v7, vcc
    v_lshl_add_u32 v166, v6, 4, v8
    s_and_b32 s52, s45, 15
    s_add_u32 s52, s52, 1
    s_mul_i32 s52, s52, 43
    s_add_u32 s52, s52, 4
    s_lshr_b32 s52, s52, 3
    s_min_u32 s52, s52, 80
    s_lshl_b32 s52, s52, 4
    s_and_b32 s53, s45, 15
    s_cmp_eq_u32 s53, 15
    s_cselect_b32 s52, 1376, s52
    s_sub_u32 s52, s52, s48
    s_cmp_eq_u32 s52, 80
    s_cselect_b32 s52, 0, -1
    s_cmp_eq_u32 s51, 1
    s_cselect_b32 s61, s52, -1
    s_waitcnt vmcnt(0) lgkmcnt(0)
    v_mul_f32 v132, 0x3b000000, v132
    v_mul_f32 v133, 0x3b000000, v133
    v_fma_f32 v133, -v132, v132, v133
    v_max_f32 v133, 0, v133
    v_cvt_pk_bf16_f32 v132, v132, v133
    v_and_b32 v133, s60, v132
    v_lshlrev_b32 v132, 16, v132
    v_add_f32 v133, 0x3727c5ac, v133
    v_cvt_pk_bf16_f32 v133, v133, v133
    v_lshlrev_b32 v133, 16, v133
    v_sqrt_f32 v133, v133
    s_nop 0
    v_cvt_pk_bf16_f32 v133, v133, v133
    v_lshlrev_b32 v133, 16, v133
    v_rcp_f32 v133, v133
    v_mul_f32 v134, 0x3b000000, v134
    v_mul_f32 v135, 0x3b000000, v135
    v_fma_f32 v135, -v134, v134, v135
    v_max_f32 v135, 0, v135
    v_cvt_pk_bf16_f32 v134, v134, v135
    v_and_b32 v135, s60, v134
    v_lshlrev_b32 v134, 16, v134
    v_add_f32 v135, 0x3727c5ac, v135
    v_cvt_pk_bf16_f32 v135, v135, v135
    v_lshlrev_b32 v135, 16, v135
    v_sqrt_f32 v135, v135
    s_nop 0
    v_cvt_pk_bf16_f32 v135, v135, v135
    v_lshlrev_b32 v135, 16, v135
    v_rcp_f32 v135, v135
    v_mul_f32 v136, 0x3b000000, v136
    v_mul_f32 v137, 0x3b000000, v137
    v_fma_f32 v137, -v136, v136, v137
    v_max_f32 v137, 0, v137
    v_cvt_pk_bf16_f32 v136, v136, v137
    v_and_b32 v137, s60, v136
    v_lshlrev_b32 v136, 16, v136
    v_add_f32 v137, 0x3727c5ac, v137
    v_cvt_pk_bf16_f32 v137, v137, v137
    v_lshlrev_b32 v137, 16, v137
    v_sqrt_f32 v137, v137
    s_nop 0
    v_cvt_pk_bf16_f32 v137, v137, v137
    v_lshlrev_b32 v137, 16, v137
    v_rcp_f32 v137, v137
    v_mul_f32 v138, 0x3b000000, v138
    v_mul_f32 v139, 0x3b000000, v139
    v_fma_f32 v139, -v138, v138, v139
    v_max_f32 v139, 0, v139
    v_cvt_pk_bf16_f32 v138, v138, v139
    v_and_b32 v139, s60, v138
    v_lshlrev_b32 v138, 16, v138
    v_add_f32 v139, 0x3727c5ac, v139
    v_cvt_pk_bf16_f32 v139, v139, v139
    v_lshlrev_b32 v139, 16, v139
    v_sqrt_f32 v139, v139
    s_nop 0
    v_cvt_pk_bf16_f32 v139, v139, v139
    v_lshlrev_b32 v139, 16, v139
    v_rcp_f32 v139, v139
    v_mul_f32 v133, v133, v133
    v_fma_f32 v16, -v132, v212, v16
    v_fma_f32 v20, -v132, v216, v20
    v_fma_f32 v17, -v132, v213, v17
    v_fma_f32 v21, -v132, v217, v21
    v_fma_f32 v18, -v132, v214, v18
    v_fma_f32 v22, -v132, v218, v22
    v_fma_f32 v19, -v132, v215, v19
    v_fma_f32 v23, -v132, v219, v23
    v_max_f32 v16, 0, v16
    v_mul_f32 v20, v20, v133
    v_max_f32 v17, 0, v17
    v_mul_f32 v21, v21, v133
    v_max_f32 v18, 0, v18
    v_mul_f32 v22, v22, v133
    v_max_f32 v19, 0, v19
    v_mul_f32 v23, v23, v133
    v_mul_f32 v16, v16, v20
    v_mul_f32 v17, v17, v21
    v_mul_f32 v18, v18, v22
    v_mul_f32 v19, v19, v23
    v_cvt_pk_bf16_f32 v142, v16, v17
    v_cvt_pk_bf16_f32 v143, v18, v19
    v_add_u32 v160, s56, v164
    ds_write_b64 v160, v[142:143]
    v_fma_f32 v24, -v132, v220, v24
    v_fma_f32 v28, -v132, v224, v28
    v_fma_f32 v25, -v132, v221, v25
    v_fma_f32 v29, -v132, v225, v29
    v_fma_f32 v26, -v132, v222, v26
    v_fma_f32 v30, -v132, v226, v30
    v_fma_f32 v27, -v132, v223, v27
    v_fma_f32 v31, -v132, v227, v31
    v_max_f32 v24, 0, v24
    v_mul_f32 v28, v28, v133
    v_max_f32 v25, 0, v25
    v_mul_f32 v29, v29, v133
    v_max_f32 v26, 0, v26
    v_mul_f32 v30, v30, v133
    v_max_f32 v27, 0, v27
    v_mul_f32 v31, v31, v133
    v_mul_f32 v24, v24, v28
    v_mul_f32 v25, v25, v29
    v_mul_f32 v26, v26, v30
    v_mul_f32 v27, v27, v31
    v_cvt_pk_bf16_f32 v144, v24, v25
    v_cvt_pk_bf16_f32 v145, v26, v27
    v_add_u32 v160, s56, v165
    ds_write_b64 v160, v[144:145]
    v_fma_f32 v32, -v132, v228, v32
    v_fma_f32 v36, -v132, v232, v36
    v_fma_f32 v33, -v132, v229, v33
    v_fma_f32 v37, -v132, v233, v37
    v_fma_f32 v34, -v132, v230, v34
    v_fma_f32 v38, -v132, v234, v38
    v_fma_f32 v35, -v132, v231, v35
    v_fma_f32 v39, -v132, v235, v39
    v_max_f32 v32, 0, v32
    v_mul_f32 v36, v36, v133
    v_max_f32 v33, 0, v33
    v_mul_f32 v37, v37, v133
    v_max_f32 v34, 0, v34
    v_mul_f32 v38, v38, v133
    v_max_f32 v35, 0, v35
    v_mul_f32 v39, v39, v133
    v_mul_f32 v32, v32, v36
    v_mul_f32 v33, v33, v37
    v_mul_f32 v34, v34, v38
    v_mul_f32 v35, v35, v39
    v_cvt_pk_bf16_f32 v146, v32, v33
    v_cvt_pk_bf16_f32 v147, v34, v35
    v_and_b32 v146, s61, v146
    v_and_b32 v147, s61, v147
    v_add_u32 v160, s56, v166
    ds_write_b64 v160, v[146:147]
    v_mul_f32 v135, v135, v135
    v_fma_f32 v40, -v134, v212, v40
    v_fma_f32 v44, -v134, v216, v44
    v_fma_f32 v41, -v134, v213, v41
    v_fma_f32 v45, -v134, v217, v45
    v_fma_f32 v42, -v134, v214, v42
    v_fma_f32 v46, -v134, v218, v46
    v_fma_f32 v43, -v134, v215, v43
    v_fma_f32 v47, -v134, v219, v47
    v_max_f32 v40, 0, v40
    v_mul_f32 v44, v44, v135
    v_max_f32 v41, 0, v41
    v_mul_f32 v45, v45, v135
    v_max_f32 v42, 0, v42
    v_mul_f32 v46, v46, v135
    v_max_f32 v43, 0, v43
    v_mul_f32 v47, v47, v135
    v_mul_f32 v40, v40, v44
    v_mul_f32 v41, v41, v45
    v_mul_f32 v42, v42, v46
    v_mul_f32 v43, v43, v47
    v_cvt_pk_bf16_f32 v148, v40, v41
    v_cvt_pk_bf16_f32 v149, v42, v43
    v_add_u32 v160, s57, v164
    ds_write_b64 v160, v[148:149]
    v_fma_f32 v48, -v134, v220, v48
    v_fma_f32 v52, -v134, v224, v52
    v_fma_f32 v49, -v134, v221, v49
    v_fma_f32 v53, -v134, v225, v53
    v_fma_f32 v50, -v134, v222, v50
    v_fma_f32 v54, -v134, v226, v54
    v_fma_f32 v51, -v134, v223, v51
    v_fma_f32 v55, -v134, v227, v55
    v_max_f32 v48, 0, v48
    v_mul_f32 v52, v52, v135
    v_max_f32 v49, 0, v49
    v_mul_f32 v53, v53, v135
    v_max_f32 v50, 0, v50
    v_mul_f32 v54, v54, v135
    v_max_f32 v51, 0, v51
    v_mul_f32 v55, v55, v135
    v_mul_f32 v48, v48, v52
    v_mul_f32 v49, v49, v53
    v_mul_f32 v50, v50, v54
    v_mul_f32 v51, v51, v55
    v_cvt_pk_bf16_f32 v150, v48, v49
    v_cvt_pk_bf16_f32 v151, v50, v51
    v_add_u32 v160, s57, v165
    ds_write_b64 v160, v[150:151]
    v_fma_f32 v56, -v134, v228, v56
    v_fma_f32 v60, -v134, v232, v60
    v_fma_f32 v57, -v134, v229, v57
    v_fma_f32 v61, -v134, v233, v61
    v_fma_f32 v58, -v134, v230, v58
    v_fma_f32 v62, -v134, v234, v62
    v_fma_f32 v59, -v134, v231, v59
    v_fma_f32 v63, -v134, v235, v63
    v_max_f32 v56, 0, v56
    v_mul_f32 v60, v60, v135
    v_max_f32 v57, 0, v57
    v_mul_f32 v61, v61, v135
    v_max_f32 v58, 0, v58
    v_mul_f32 v62, v62, v135
    v_max_f32 v59, 0, v59
    v_mul_f32 v63, v63, v135
    v_mul_f32 v56, v56, v60
    v_mul_f32 v57, v57, v61
    v_mul_f32 v58, v58, v62
    v_mul_f32 v59, v59, v63
    v_cvt_pk_bf16_f32 v152, v56, v57
    v_cvt_pk_bf16_f32 v153, v58, v59
    v_and_b32 v152, s61, v152
    v_and_b32 v153, s61, v153
    v_add_u32 v160, s57, v166
    ds_write_b64 v160, v[152:153]
    v_mul_f32 v137, v137, v137
    v_fma_f32 v64, -v136, v212, v64
    v_fma_f32 v68, -v136, v216, v68
    v_fma_f32 v65, -v136, v213, v65
    v_fma_f32 v69, -v136, v217, v69
    v_fma_f32 v66, -v136, v214, v66
    v_fma_f32 v70, -v136, v218, v70
    v_fma_f32 v67, -v136, v215, v67
    v_fma_f32 v71, -v136, v219, v71
    v_max_f32 v64, 0, v64
    v_mul_f32 v68, v68, v137
    v_max_f32 v65, 0, v65
    v_mul_f32 v69, v69, v137
    v_max_f32 v66, 0, v66
    v_mul_f32 v70, v70, v137
    v_max_f32 v67, 0, v67
    v_mul_f32 v71, v71, v137
    v_mul_f32 v64, v64, v68
    v_mul_f32 v65, v65, v69
    v_mul_f32 v66, v66, v70
    v_mul_f32 v67, v67, v71
    v_cvt_pk_bf16_f32 v154, v64, v65
    v_cvt_pk_bf16_f32 v155, v66, v67
    v_add_u32 v160, s58, v164
    ds_write_b64 v160, v[154:155]
    v_fma_f32 v72, -v136, v220, v72
    v_fma_f32 v76, -v136, v224, v76
    v_fma_f32 v73, -v136, v221, v73
    v_fma_f32 v77, -v136, v225, v77
    v_fma_f32 v74, -v136, v222, v74
    v_fma_f32 v78, -v136, v226, v78
    v_fma_f32 v75, -v136, v223, v75
    v_fma_f32 v79, -v136, v227, v79
    v_max_f32 v72, 0, v72
    v_mul_f32 v76, v76, v137
    v_max_f32 v73, 0, v73
    v_mul_f32 v77, v77, v137
    v_max_f32 v74, 0, v74
    v_mul_f32 v78, v78, v137
    v_max_f32 v75, 0, v75
    v_mul_f32 v79, v79, v137
    v_mul_f32 v72, v72, v76
    v_mul_f32 v73, v73, v77
    v_mul_f32 v74, v74, v78
    v_mul_f32 v75, v75, v79
    v_cvt_pk_bf16_f32 v156, v72, v73
    v_cvt_pk_bf16_f32 v157, v74, v75
    v_add_u32 v160, s58, v165
    ds_write_b64 v160, v[156:157]
    v_fma_f32 v80, -v136, v228, v80
    v_fma_f32 v84, -v136, v232, v84
    v_fma_f32 v81, -v136, v229, v81
    v_fma_f32 v85, -v136, v233, v85
    v_fma_f32 v82, -v136, v230, v82
    v_fma_f32 v86, -v136, v234, v86
    v_fma_f32 v83, -v136, v231, v83
    v_fma_f32 v87, -v136, v235, v87
    v_max_f32 v80, 0, v80
    v_mul_f32 v84, v84, v137
    v_max_f32 v81, 0, v81
    v_mul_f32 v85, v85, v137
    v_max_f32 v82, 0, v82
    v_mul_f32 v86, v86, v137
    v_max_f32 v83, 0, v83
    v_mul_f32 v87, v87, v137
    v_mul_f32 v80, v80, v84
    v_mul_f32 v81, v81, v85
    v_mul_f32 v82, v82, v86
    v_mul_f32 v83, v83, v87
    v_cvt_pk_bf16_f32 v142, v80, v81
    v_cvt_pk_bf16_f32 v143, v82, v83
    v_and_b32 v142, s61, v142
    v_and_b32 v143, s61, v143
    v_add_u32 v160, s58, v166
    ds_write_b64 v160, v[142:143]
    v_mul_f32 v139, v139, v139
    v_fma_f32 v88, -v138, v212, v88
    v_fma_f32 v92, -v138, v216, v92
    v_fma_f32 v89, -v138, v213, v89
    v_fma_f32 v93, -v138, v217, v93
    v_fma_f32 v90, -v138, v214, v90
    v_fma_f32 v94, -v138, v218, v94
    v_fma_f32 v91, -v138, v215, v91
    v_fma_f32 v95, -v138, v219, v95
    v_max_f32 v88, 0, v88
    v_mul_f32 v92, v92, v139
    v_max_f32 v89, 0, v89
    v_mul_f32 v93, v93, v139
    v_max_f32 v90, 0, v90
    v_mul_f32 v94, v94, v139
    v_max_f32 v91, 0, v91
    v_mul_f32 v95, v95, v139
    v_mul_f32 v88, v88, v92
    v_mul_f32 v89, v89, v93
    v_mul_f32 v90, v90, v94
    v_mul_f32 v91, v91, v95
    v_cvt_pk_bf16_f32 v144, v88, v89
    v_cvt_pk_bf16_f32 v145, v90, v91
    v_add_u32 v160, s59, v164
    ds_write_b64 v160, v[144:145]
    v_fma_f32 v96, -v138, v220, v96
    v_fma_f32 v100, -v138, v224, v100
    v_fma_f32 v97, -v138, v221, v97
    v_fma_f32 v101, -v138, v225, v101
    v_fma_f32 v98, -v138, v222, v98
    v_fma_f32 v102, -v138, v226, v102
    v_fma_f32 v99, -v138, v223, v99
    v_fma_f32 v103, -v138, v227, v103
    v_max_f32 v96, 0, v96
    v_mul_f32 v100, v100, v139
    v_max_f32 v97, 0, v97
    v_mul_f32 v101, v101, v139
    v_max_f32 v98, 0, v98
    v_mul_f32 v102, v102, v139
    v_max_f32 v99, 0, v99
    v_mul_f32 v103, v103, v139
    v_mul_f32 v96, v96, v100
    v_mul_f32 v97, v97, v101
    v_mul_f32 v98, v98, v102
    v_mul_f32 v99, v99, v103
    v_cvt_pk_bf16_f32 v146, v96, v97
    v_cvt_pk_bf16_f32 v147, v98, v99
    v_add_u32 v160, s59, v165
    ds_write_b64 v160, v[146:147]
    v_fma_f32 v104, -v138, v228, v104
    v_fma_f32 v108, -v138, v232, v108
    v_fma_f32 v105, -v138, v229, v105
    v_fma_f32 v109, -v138, v233, v109
    v_fma_f32 v106, -v138, v230, v106
    v_fma_f32 v110, -v138, v234, v110
    v_fma_f32 v107, -v138, v231, v107
    v_fma_f32 v111, -v138, v235, v111
    v_max_f32 v104, 0, v104
    v_mul_f32 v108, v108, v139
    v_max_f32 v105, 0, v105
    v_mul_f32 v109, v109, v139
    v_max_f32 v106, 0, v106
    v_mul_f32 v110, v110, v139
    v_max_f32 v107, 0, v107
    v_mul_f32 v111, v111, v139
    v_mul_f32 v104, v104, v108
    v_mul_f32 v105, v105, v109
    v_mul_f32 v106, v106, v110
    v_mul_f32 v107, v107, v111
    v_cvt_pk_bf16_f32 v148, v104, v105
    v_cvt_pk_bf16_f32 v149, v106, v107
    v_and_b32 v148, s61, v148
    v_and_b32 v149, s61, v149
    v_add_u32 v160, s59, v166
    ds_write_b64 v160, v[148:149]
    v_lshlrev_b32 v16, 4, v0
    s_mul_i32 s52, s45, 24576
    s_add_u32 s52, s52, 0x600000
    s_add_u32 s53, s52, 12288
    s_waitcnt lgkmcnt(0)
    s_barrier
    ds_read_b128 v[32:35], v16 offset:1024
    ds_read_b128 v[36:39], v16 offset:5120
    ds_read_b128 v[40:43], v16 offset:9216
    ds_read_b128 v[44:47], v16 offset:13312
    ds_read_b128 v[48:51], v16 offset:17408
    ds_read_b128 v[52:55], v16 offset:21504
    s_waitcnt lgkmcnt(5)
    s_add_u32 s53, s52, 0
    buffer_store_dwordx4 v[32:35], v16, s[8:11], s53 offen sc1
    s_waitcnt lgkmcnt(4)
    s_add_u32 s53, s52, 4096
    buffer_store_dwordx4 v[36:39], v16, s[8:11], s53 offen sc1
    s_waitcnt lgkmcnt(3)
    s_add_u32 s53, s52, 8192
    buffer_store_dwordx4 v[40:43], v16, s[8:11], s53 offen sc1
    s_waitcnt lgkmcnt(2)
    s_add_u32 s53, s52, 12288
    buffer_store_dwordx4 v[44:47], v16, s[8:11], s53 offen sc1
    s_waitcnt lgkmcnt(1)
    s_add_u32 s53, s52, 16384
    buffer_store_dwordx4 v[48:51], v16, s[8:11], s53 offen sc1
    s_waitcnt lgkmcnt(0)
    s_add_u32 s53, s52, 20480
    buffer_store_dwordx4 v[52:55], v16, s[8:11], s53 offen sc1
    s_waitcnt vmcnt(0) lgkmcnt(0)
    s_barrier
    s_cmp_lg_u32 s44, 0
    s_cbranch_scc1 PUB_40
    s_mov_b64 exec, 1
    s_lshl_b32 s96, s49, 7
    s_add_u32 s96, s96, 0xc10000
    v_mov_b32 v252, s96
    v_mov_b32 v253, 1
    buffer_atomic_add v253, v252, s[8:11], 0 offen sc1
    s_mov_b64 exec, -1
PUB_40:
    s_mov_b32 s12, s38
    s_and_b32 s13, s39, 0xffff
    s_mov_b32 s14, 0x200000
    s_mov_b32 s15, 0x00020000
    s_and_b32 s50, s44, 1
    s_lshr_b32 s51, s44, 1
    v_lshrrev_b32 v5, 2, v3
    v_and_b32 v6, 3, v3
    v_lshrrev_b32 v7, 3, v3
    v_lshl_add_u32 v7, v7, 1, v4
    s_lshl_b32 s52, s50, 5
    v_add_u32 v8, s52, v3
    v_mul_u32_u24 v8, 192, v8
    v_add_u32 v9, 0, v7
    v_subrev_u32 v13, 12, v9
    v_cmp_le_u32 vcc, 12, v9
    s_nop 1
    v_cndmask_b32 v9, v9, v13, vcc
    v_lshl_add_u32 v10, v9, 4, v8
    v_add_u32 v9, 4, v7
    v_subrev_u32 v13, 12, v9
    v_cmp_le_u32 vcc, 12, v9
    s_nop 1
    v_cndmask_b32 v9, v9, v13, vcc
    v_lshl_add_u32 v11, v9, 4, v8
    v_add_u32 v9, 8, v7
    v_subrev_u32 v13, 12, v9
    v_cmp_le_u32 vcc, 12, v9
    s_nop 1
    v_cndmask_b32 v9, v9, v13, vcc
    v_lshl_add_u32 v12, v9, 4, v8
    v_lshrrev_b32 v7, 1, v5
    v_and_b32 v8, 1, v4
    v_lshl_or_b32 v7, v8, 1, v7
    v_lshl_add_u32 v8, v4, 3, v5
    s_lshl_b32 s52, s51, 1
    s_add_u32 s52, s52, 0
    v_xor_b32 v9, s52, v7
    v_lshlrev_b32 v9, 5, v9
    v_lshl_add_u32 v9, v6, 3, v9
    v_lshl_add_u32 v9, v8, 7, v9
    v_add_u32 v14, 0x12000, v9
    s_lshl_b32 s52, s51, 1
    s_add_u32 s52, s52, 1
    v_xor_b32 v9, s52, v7
    v_lshlrev_b32 v9, 5, v9
    v_lshl_add_u32 v9, v6, 3, v9
    v_lshl_add_u32 v9, v8, 7, v9
    v_add_u32 v15, 0x12000, v9
    v_mov_b32 v16, 0
    v_mov_b32 v17, 0
    v_mov_b32 v18, 0
    v_mov_b32 v19, 0
    v_mov_b32 v20, 0
    v_mov_b32 v21, 0
    v_mov_b32 v22, 0
    v_mov_b32 v23, 0
    v_mov_b32 v24, 0
    v_mov_b32 v25, 0
    v_mov_b32 v26, 0
    v_mov_b32 v27, 0
    v_mov_b32 v28, 0
    v_mov_b32 v29, 0
    v_mov_b32 v30, 0
    v_mov_b32 v31, 0
    s_cmp_lg_u32 s44, 0
    s_cbranch_scc1 POLLB_41
    s_lshl_b32 s96, s49, 7
    s_add_u32 s96, s96, 0xc10000
    v_mov_b32 v252, s96
    s_mov_b32 s96, 16
    s_mov_b32 s97, 0
POLL_42:
    buffer_load_dword v253, v252, s[8:11], 0 offen sc1
    s_waitcnt vmcnt(0)
    v_cmp_ne_u32 vcc, s96, v253
    s_add_u32 s97, s97, 1
    s_nop 3
    s_cmp_eq_u64 vcc, 0
    s_cbranch_scc1 POLLE_43
    s_cmp_gt_u32 s97, 0x200000
    s_cbranch_scc1 POLLE_43
    s_sleep 1
    s_branch POLL_42
POLLE_43:
POLLB_41:
    s_barrier
    s_barrier
    ds_read_b128 v[32:35], v10 offset:0
    ds_read_b128 v[36:39], v10 offset:3072
    ds_read_b64_tr_b16 v[40:41], v14 offset:0
    ds_read_b64_tr_b16 v[42:43], v14 offset:512
    ds_read_b64_tr_b16 v[44:45], v15 offset:0
    ds_read_b64_tr_b16 v[46:47], v15 offset:512
    ds_read_b128 v[48:51], v11 offset:0
    ds_read_b128 v[52:55], v11 offset:3072
    ds_read_b64_tr_b16 v[56:57], v14 offset:4096
    ds_read_b64_tr_b16 v[58:59], v14 offset:4608
    ds_read_b64_tr_b16 v[60:61], v15 offset:4096
    ds_read_b64_tr_b16 v[62:63], v15 offset:4608
    s_waitcnt lgkmcnt(6)
    v_mfma_f32_16x16x32_bf16 v[16:19], v[40:43], v[32:35], v[16:19]
    ds_read_b128 v[64:67], v12 offset:0
    ds_read_b128 v[68:71], v12 offset:3072
    v_mfma_f32_16x16x32_bf16 v[20:23], v[40:43], v[36:39], v[20:23]
    ds_read_b64_tr_b16 v[72:73], v14 offset:8192
    ds_read_b64_tr_b16 v[74:75], v14 offset:8704
    v_mfma_f32_16x16x32_bf16 v[24:27], v[44:47], v[32:35], v[24:27]
    ds_read_b64_tr_b16 v[76:77], v15 offset:8192
    ds_read_b64_tr_b16 v[78:79], v15 offset:8704
    v_mfma_f32_16x16x32_bf16 v[28:31], v[44:47], v[36:39], v[28:31]
    s_waitcnt lgkmcnt(6)
    v_mfma_f32_16x16x32_bf16 v[16:19], v[56:59], v[48:51], v[16:19]
    v_add_u32 v10, 12288, v10
    v_add_u32 v11, 12288, v11
    v_add_u32 v12, 12288, v12
    v_add_u32 v14, 12288, v14
    v_add_u32 v15, 12288, v15
    s_barrier
    v_mfma_f32_16x16x32_bf16 v[20:23], v[56:59], v[52:55], v[20:23]
    ds_read_b128 v[32:35], v10 offset:0
    ds_read_b128 v[36:39], v10 offset:3072
    v_mfma_f32_16x16x32_bf16 v[24:27], v[60:63], v[48:51], v[24:27]
    ds_read_b64_tr_b16 v[40:41], v14 offset:0
    ds_read_b64_tr_b16 v[42:43], v14 offset:512
    v_mfma_f32_16x16x32_bf16 v[28:31], v[60:63], v[52:55], v[28:31]
    ds_read_b64_tr_b16 v[44:45], v15 offset:0
    ds_read_b64_tr_b16 v[46:47], v15 offset:512
    s_waitcnt lgkmcnt(6)
    v_mfma_f32_16x16x32_bf16 v[16:19], v[72:75], v[64:67], v[16:19]
    ds_read_b128 v[48:51], v11 offset:0
    ds_read_b128 v[52:55], v11 offset:3072
    v_mfma_f32_16x16x32_bf16 v[20:23], v[72:75], v[68:71], v[20:23]
    ds_read_b64_tr_b16 v[56:57], v14 offset:4096
    ds_read_b64_tr_b16 v[58:59], v14 offset:4608
    v_mfma_f32_16x16x32_bf16 v[24:27], v[76:79], v[64:67], v[24:27]
    ds_read_b64_tr_b16 v[60:61], v15 offset:4096
    ds_read_b64_tr_b16 v[62:63], v15 offset:4608
    v_mfma_f32_16x16x32_bf16 v[28:31], v[76:79], v[68:71], v[28:31]
    s_waitcnt lgkmcnt(6)
    v_mfma_f32_16x16x32_bf16 v[16:19], v[40:43], v[32:35], v[16:19]
    ds_read_b128 v[64:67], v12 offset:0
    ds_read_b128 v[68:71], v12 offset:3072
    v_mfma_f32_16x16x32_bf16 v[20:23], v[40:43], v[36:39], v[20:23]
    ds_read_b64_tr_b16 v[72:73], v14 offset:8192
    ds_read_b64_tr_b16 v[74:75], v14 offset:8704
    v_mfma_f32_16x16x32_bf16 v[24:27], v[44:47], v[32:35], v[24:27]
    ds_read_b64_tr_b16 v[76:77], v15 offset:8192
    ds_read_b64_tr_b16 v[78:79], v15 offset:8704
    v_mfma_f32_16x16x32_bf16 v[28:31], v[44:47], v[36:39], v[28:31]
    s_waitcnt lgkmcnt(6)
    v_mfma_f32_16x16x32_bf16 v[16:19], v[56:59], v[48:51], v[16:19]
    v_add_u32 v10, 12288, v10
    v_add_u32 v11, 12288, v11
    v_add_u32 v12, 12288, v12
    v_add_u32 v14, 12288, v14
    v_add_u32 v15, 12288, v15
    s_barrier
    v_mfma_f32_16x16x32_bf16 v[20:23], v[56:59], v[52:55], v[20:23]
    ds_read_b128 v[32:35], v10 offset:0
    ds_read_b128 v[36:39], v10 offset:3072
    v_mfma_f32_16x16x32_bf16 v[24:27], v[60:63], v[48:51], v[24:27]
    ds_read_b64_tr_b16 v[40:41], v14 offset:0
    ds_read_b64_tr_b16 v[42:43], v14 offset:512
    v_mfma_f32_16x16x32_bf16 v[28:31], v[60:63], v[52:55], v[28:31]
    ds_read_b64_tr_b16 v[44:45], v15 offset:0
    ds_read_b64_tr_b16 v[46:47], v15 offset:512
    s_waitcnt lgkmcnt(6)
    v_mfma_f32_16x16x32_bf16 v[16:19], v[72:75], v[64:67], v[16:19]
    ds_read_b128 v[48:51], v11 offset:0
    ds_read_b128 v[52:55], v11 offset:3072
    v_mfma_f32_16x16x32_bf16 v[20:23], v[72:75], v[68:71], v[20:23]
    ds_read_b64_tr_b16 v[56:57], v14 offset:4096
    ds_read_b64_tr_b16 v[58:59], v14 offset:4608
    v_mfma_f32_16x16x32_bf16 v[24:27], v[76:79], v[64:67], v[24:27]
    ds_read_b64_tr_b16 v[60:61], v15 offset:4096
    ds_read_b64_tr_b16 v[62:63], v15 offset:4608
    v_mfma_f32_16x16x32_bf16 v[28:31], v[76:79], v[68:71], v[28:31]
    s_waitcnt lgkmcnt(6)
    v_mfma_f32_16x16x32_bf16 v[16:19], v[40:43], v[32:35], v[16:19]
    ds_read_b128 v[64:67], v12 offset:0
    ds_read_b128 v[68:71], v12 offset:3072
    v_mfma_f32_16x16x32_bf16 v[20:23], v[40:43], v[36:39], v[20:23]
    ds_read_b64_tr_b16 v[72:73], v14 offset:8192
    ds_read_b64_tr_b16 v[74:75], v14 offset:8704
    v_mfma_f32_16x16x32_bf16 v[24:27], v[44:47], v[32:35], v[24:27]
    ds_read_b64_tr_b16 v[76:77], v15 offset:8192
    ds_read_b64_tr_b16 v[78:79], v15 offset:8704
    v_mfma_f32_16x16x32_bf16 v[28:31], v[44:47], v[36:39], v[28:31]
    s_waitcnt lgkmcnt(6)
    v_mfma_f32_16x16x32_bf16 v[16:19], v[56:59], v[48:51], v[16:19]
    v_add_u32 v10, 12288, v10
    v_add_u32 v11, 12288, v11
    v_add_u32 v12, 12288, v12
    v_add_u32 v14, 12288, v14
    v_add_u32 v15, 12288, v15
    s_barrier
    v_mfma_f32_16x16x32_bf16 v[20:23], v[56:59], v[52:55], v[20:23]
    ds_read_b128 v[32:35], v10 offset:0
    ds_read_b128 v[36:39], v10 offset:3072
    v_mfma_f32_16x16x32_bf16 v[24:27], v[60:63], v[48:51], v[24:27]
    ds_read_b64_tr_b16 v[40:41], v14 offset:0
    ds_read_b64_tr_b16 v[42:43], v14 offset:512
    v_mfma_f32_16x16x32_bf16 v[28:31], v[60:63], v[52:55], v[28:31]
    ds_read_b64_tr_b16 v[44:45], v15 offset:0
    ds_read_b64_tr_b16 v[46:47], v15 offset:512
    s_waitcnt lgkmcnt(6)
    v_mfma_f32_16x16x32_bf16 v[16:19], v[72:75], v[64:67], v[16:19]
    ds_read_b128 v[48:51], v11 offset:0
    ds_read_b128 v[52:55], v11 offset:3072
    v_mfma_f32_16x16x32_bf16 v[20:23], v[72:75], v[68:71], v[20:23]
    ds_read_b64_tr_b16 v[56:57], v14 offset:4096
    ds_read_b64_tr_b16 v[58:59], v14 offset:4608
    v_mfma_f32_16x16x32_bf16 v[24:27], v[76:79], v[64:67], v[24:27]
    ds_read_b64_tr_b16 v[60:61], v15 offset:4096
    ds_read_b64_tr_b16 v[62:63], v15 offset:4608
    v_mfma_f32_16x16x32_bf16 v[28:31], v[76:79], v[68:71], v[28:31]
    s_waitcnt lgkmcnt(6)
    v_mfma_f32_16x16x32_bf16 v[16:19], v[40:43], v[32:35], v[16:19]
    ds_read_b128 v[64:67], v12 offset:0
    ds_read_b128 v[68:71], v12 offset:3072
    v_mfma_f32_16x16x32_bf16 v[20:23], v[40:43], v[36:39], v[20:23]
    ds_read_b64_tr_b16 v[72:73], v14 offset:8192
    ds_read_b64_tr_b16 v[74:75], v14 offset:8704
    v_mfma_f32_16x16x32_bf16 v[24:27], v[44:47], v[32:35], v[24:27]
    ds_read_b64_tr_b16 v[76:77], v15 offset:8192
    ds_read_b64_tr_b16 v[78:79], v15 offset:8704
    v_mfma_f32_16x16x32_bf16 v[28:31], v[44:47], v[36:39], v[28:31]
    s_waitcnt lgkmcnt(6)
    v_mfma_f32_16x16x32_bf16 v[16:19], v[56:59], v[48:51], v[16:19]
    v_add_u32 v10, 12288, v10
    v_add_u32 v11, 12288, v11
    v_add_u32 v12, 12288, v12
    v_add_u32 v14, 12288, v14
    v_add_u32 v15, 12288, v15
    s_barrier
    v_mfma_f32_16x16x32_bf16 v[20:23], v[56:59], v[52:55], v[20:23]
    ds_read_b128 v[32:35], v10 offset:0
    ds_read_b128 v[36:39], v10 offset:3072
    v_mfma_f32_16x16x32_bf16 v[24:27], v[60:63], v[48:51], v[24:27]
    ds_read_b64_tr_b16 v[40:41], v14 offset:0
    ds_read_b64_tr_b16 v[42:43], v14 offset:512
    v_mfma_f32_16x16x32_bf16 v[28:31], v[60:63], v[52:55], v[28:31]
    ds_read_b64_tr_b16 v[44:45], v15 offset:0
    ds_read_b64_tr_b16 v[46:47], v15 offset:512
    s_waitcnt lgkmcnt(6)
    v_mfma_f32_16x16x32_bf16 v[16:19], v[72:75], v[64:67], v[16:19]
    ds_read_b128 v[48:51], v11 offset:0
    ds_read_b128 v[52:55], v11 offset:3072
    v_mfma_f32_16x16x32_bf16 v[20:23], v[72:75], v[68:71], v[20:23]
    ds_read_b64_tr_b16 v[56:57], v14 offset:4096
    ds_read_b64_tr_b16 v[58:59], v14 offset:4608
    v_mfma_f32_16x16x32_bf16 v[24:27], v[76:79], v[64:67], v[24:27]
    ds_read_b64_tr_b16 v[60:61], v15 offset:4096
    ds_read_b64_tr_b16 v[62:63], v15 offset:4608
    v_mfma_f32_16x16x32_bf16 v[28:31], v[76:79], v[68:71], v[28:31]
    s_waitcnt lgkmcnt(6)
    v_mfma_f32_16x16x32_bf16 v[16:19], v[40:43], v[32:35], v[16:19]
    ds_read_b128 v[64:67], v12 offset:0
    ds_read_b128 v[68:71], v12 offset:3072
    v_mfma_f32_16x16x32_bf16 v[20:23], v[40:43], v[36:39], v[20:23]
    ds_read_b64_tr_b16 v[72:73], v14 offset:8192
    ds_read_b64_tr_b16 v[74:75], v14 offset:8704
    v_mfma_f32_16x16x32_bf16 v[24:27], v[44:47], v[32:35], v[24:27]
    ds_read_b64_tr_b16 v[76:77], v15 offset:8192
    ds_read_b64_tr_b16 v[78:79], v15 offset:8704
    v_mfma_f32_16x16x32_bf16 v[28:31], v[44:47], v[36:39], v[28:31]
    s_waitcnt lgkmcnt(6)
    v_mfma_f32_16x16x32_bf16 v[16:19], v[56:59], v[48:51], v[16:19]
    v_subrev_u32 v10, 49152, v10
    v_subrev_u32 v11, 49152, v11
    v_subrev_u32 v12, 49152, v12
    v_add_u32 v14, 12288, v14
    v_add_u32 v15, 12288, v15
    s_barrier
    v_mfma_f32_16x16x32_bf16 v[20:23], v[56:59], v[52:55], v[20:23]
    ds_read_b128 v[32:35], v10 offset:0
    ds_read_b128 v[36:39], v10 offset:3072
    v_mfma_f32_16x16x32_bf16 v[24:27], v[60:63], v[48:51], v[24:27]
    ds_read_b64_tr_b16 v[40:41], v14 offset:0
    ds_read_b64_tr_b16 v[42:43], v14 offset:512
    v_mfma_f32_16x16x32_bf16 v[28:31], v[60:63], v[52:55], v[28:31]
    ds_read_b64_tr_b16 v[44:45], v15 offset:0
    ds_read_b64_tr_b16 v[46:47], v15 offset:512
    s_waitcnt lgkmcnt(6)
    v_mfma_f32_16x16x32_bf16 v[16:19], v[72:75], v[64:67], v[16:19]
    ds_read_b128 v[48:51], v11 offset:0
    ds_read_b128 v[52:55], v11 offset:3072
    v_mfma_f32_16x16x32_bf16 v[20:23], v[72:75], v[68:71], v[20:23]
    ds_read_b64_tr_b16 v[56:57], v14 offset:4096
    ds_read_b64_tr_b16 v[58:59], v14 offset:4608
    v_mfma_f32_16x16x32_bf16 v[24:27], v[76:79], v[64:67], v[24:27]
    ds_read_b64_tr_b16 v[60:61], v15 offset:4096
    ds_read_b64_tr_b16 v[62:63], v15 offset:4608
    v_mfma_f32_16x16x32_bf16 v[28:31], v[76:79], v[68:71], v[28:31]
    s_waitcnt lgkmcnt(6)
    v_mfma_f32_16x16x32_bf16 v[16:19], v[40:43], v[32:35], v[16:19]
    ds_read_b128 v[64:67], v12 offset:0
    ds_read_b128 v[68:71], v12 offset:3072
    v_mfma_f32_16x16x32_bf16 v[20:23], v[40:43], v[36:39], v[20:23]
    ds_read_b64_tr_b16 v[72:73], v14 offset:8192
    ds_read_b64_tr_b16 v[74:75], v14 offset:8704
    v_mfma_f32_16x16x32_bf16 v[24:27], v[44:47], v[32:35], v[24:27]
    ds_read_b64_tr_b16 v[76:77], v15 offset:8192
    ds_read_b64_tr_b16 v[78:79], v15 offset:8704
    v_mfma_f32_16x16x32_bf16 v[28:31], v[44:47], v[36:39], v[28:31]
    s_waitcnt lgkmcnt(6)
    v_mfma_f32_16x16x32_bf16 v[16:19], v[56:59], v[48:51], v[16:19]
    v_add_u32 v10, 12288, v10
    v_add_u32 v11, 12288, v11
    v_add_u32 v12, 12288, v12
    v_add_u32 v14, 12288, v14
    v_add_u32 v15, 12288, v15
    s_barrier
    v_mfma_f32_16x16x32_bf16 v[20:23], v[56:59], v[52:55], v[20:23]
    ds_read_b128 v[32:35], v10 offset:0
    ds_read_b128 v[36:39], v10 offset:3072
    v_mfma_f32_16x16x32_bf16 v[24:27], v[60:63], v[48:51], v[24:27]
    ds_read_b64_tr_b16 v[40:41], v14 offset:0
    ds_read_b64_tr_b16 v[42:43], v14 offset:512
    v_mfma_f32_16x16x32_bf16 v[28:31], v[60:63], v[52:55], v[28:31]
    ds_read_b64_tr_b16 v[44:45], v15 offset:0
    ds_read_b64_tr_b16 v[46:47], v15 offset:512
    s_waitcnt lgkmcnt(6)
    v_mfma_f32_16x16x32_bf16 v[16:19], v[72:75], v[64:67], v[16:19]
    ds_read_b128 v[48:51], v11 offset:0
    ds_read_b128 v[52:55], v11 offset:3072
    v_mfma_f32_16x16x32_bf16 v[20:23], v[72:75], v[68:71], v[20:23]
    ds_read_b64_tr_b16 v[56:57], v14 offset:4096
    ds_read_b64_tr_b16 v[58:59], v14 offset:4608
    v_mfma_f32_16x16x32_bf16 v[24:27], v[76:79], v[64:67], v[24:27]
    ds_read_b64_tr_b16 v[60:61], v15 offset:4096
    ds_read_b64_tr_b16 v[62:63], v15 offset:4608
    v_mfma_f32_16x16x32_bf16 v[28:31], v[76:79], v[68:71], v[28:31]
    s_waitcnt lgkmcnt(6)
    v_mfma_f32_16x16x32_bf16 v[16:19], v[40:43], v[32:35], v[16:19]
    ds_read_b128 v[64:67], v12 offset:0
    ds_read_b128 v[68:71], v12 offset:3072
    v_mfma_f32_16x16x32_bf16 v[20:23], v[40:43], v[36:39], v[20:23]
    ds_read_b64_tr_b16 v[72:73], v14 offset:8192
    ds_read_b64_tr_b16 v[74:75], v14 offset:8704
    v_mfma_f32_16x16x32_bf16 v[24:27], v[44:47], v[32:35], v[24:27]
    ds_read_b64_tr_b16 v[76:77], v15 offset:8192
    ds_read_b64_tr_b16 v[78:79], v15 offset:8704
    v_mfma_f32_16x16x32_bf16 v[28:31], v[44:47], v[36:39], v[28:31]
    s_waitcnt lgkmcnt(6)
    v_mfma_f32_16x16x32_bf16 v[16:19], v[56:59], v[48:51], v[16:19]
    v_add_u32 v10, 12288, v10
    v_add_u32 v11, 12288, v11
    v_add_u32 v12, 12288, v12
    v_subrev_u32 v14, 73728, v14
    v_subrev_u32 v15, 73728, v15
    s_barrier
    v_mfma_f32_16x16x32_bf16 v[20:23], v[56:59], v[52:55], v[20:23]
    ds_read_b128 v[32:35], v10 offset:0
    ds_read_b128 v[36:39], v10 offset:3072
    v_mfma_f32_16x16x32_bf16 v[24:27], v[60:63], v[48:51], v[24:27]
    ds_read_b64_tr_b16 v[40:41], v14 offset:0
    ds_read_b64_tr_b16 v[42:43], v14 offset:512
    v_mfma_f32_16x16x32_bf16 v[28:31], v[60:63], v[52:55], v[28:31]
    ds_read_b64_tr_b16 v[44:45], v15 offset:0
    ds_read_b64_tr_b16 v[46:47], v15 offset:512
    s_waitcnt lgkmcnt(6)
    v_mfma_f32_16x16x32_bf16 v[16:19], v[72:75], v[64:67], v[16:19]
    ds_read_b128 v[48:51], v11 offset:0
    ds_read_b128 v[52:55], v11 offset:3072
    v_mfma_f32_16x16x32_bf16 v[20:23], v[72:75], v[68:71], v[20:23]
    ds_read_b64_tr_b16 v[56:57], v14 offset:4096
    ds_read_b64_tr_b16 v[58:59], v14 offset:4608
    v_mfma_f32_16x16x32_bf16 v[24:27], v[76:79], v[64:67], v[24:27]
    ds_read_b64_tr_b16 v[60:61], v15 offset:4096
    ds_read_b64_tr_b16 v[62:63], v15 offset:4608
    v_mfma_f32_16x16x32_bf16 v[28:31], v[76:79], v[68:71], v[28:31]
    s_waitcnt lgkmcnt(6)
    v_mfma_f32_16x16x32_bf16 v[16:19], v[40:43], v[32:35], v[16:19]
    ds_read_b128 v[64:67], v12 offset:0
    ds_read_b128 v[68:71], v12 offset:3072
    v_mfma_f32_16x16x32_bf16 v[20:23], v[40:43], v[36:39], v[20:23]
    ds_read_b64_tr_b16 v[72:73], v14 offset:8192
    ds_read_b64_tr_b16 v[74:75], v14 offset:8704
    v_mfma_f32_16x16x32_bf16 v[24:27], v[44:47], v[32:35], v[24:27]
    ds_read_b64_tr_b16 v[76:77], v15 offset:8192
    ds_read_b64_tr_b16 v[78:79], v15 offset:8704
    v_mfma_f32_16x16x32_bf16 v[28:31], v[44:47], v[36:39], v[28:31]
    s_waitcnt lgkmcnt(6)
    v_mfma_f32_16x16x32_bf16 v[16:19], v[56:59], v[48:51], v[16:19]
    v_add_u32 v10, 12288, v10
    v_add_u32 v11, 12288, v11
    v_add_u32 v12, 12288, v12
    v_add_u32 v14, 12288, v14
    v_add_u32 v15, 12288, v15
    s_barrier
    v_mfma_f32_16x16x32_bf16 v[20:23], v[56:59], v[52:55], v[20:23]
    ds_read_b128 v[32:35], v10 offset:0
    ds_read_b128 v[36:39], v10 offset:3072
    v_mfma_f32_16x16x32_bf16 v[24:27], v[60:63], v[48:51], v[24:27]
    ds_read_b64_tr_b16 v[40:41], v14 offset:0
    ds_read_b64_tr_b16 v[42:43], v14 offset:512
    v_mfma_f32_16x16x32_bf16 v[28:31], v[60:63], v[52:55], v[28:31]
    ds_read_b64_tr_b16 v[44:45], v15 offset:0
    ds_read_b64_tr_b16 v[46:47], v15 offset:512
    s_waitcnt lgkmcnt(6)
    v_mfma_f32_16x16x32_bf16 v[16:19], v[72:75], v[64:67], v[16:19]
    ds_read_b128 v[48:51], v11 offset:0
    ds_read_b128 v[52:55], v11 offset:3072
    v_mfma_f32_16x16x32_bf16 v[20:23], v[72:75], v[68:71], v[20:23]
    ds_read_b64_tr_b16 v[56:57], v14 offset:4096
    ds_read_b64_tr_b16 v[58:59], v14 offset:4608
    v_mfma_f32_16x16x32_bf16 v[24:27], v[76:79], v[64:67], v[24:27]
    ds_read_b64_tr_b16 v[60:61], v15 offset:4096
    ds_read_b64_tr_b16 v[62:63], v15 offset:4608
    v_mfma_f32_16x16x32_bf16 v[28:31], v[76:79], v[68:71], v[28:31]
    s_waitcnt lgkmcnt(6)
    v_mfma_f32_16x16x32_bf16 v[16:19], v[40:43], v[32:35], v[16:19]
    ds_read_b128 v[64:67], v12 offset:0
    ds_read_b128 v[68:71], v12 offset:3072
    v_mfma_f32_16x16x32_bf16 v[20:23], v[40:43], v[36:39], v[20:23]
    ds_read_b64_tr_b16 v[72:73], v14 offset:8192
    ds_read_b64_tr_b16 v[74:75], v14 offset:8704
    v_mfma_f32_16x16x32_bf16 v[24:27], v[44:47], v[32:35], v[24:27]
    ds_read_b64_tr_b16 v[76:77], v15 offset:8192
    ds_read_b64_tr_b16 v[78:79], v15 offset:8704
    v_mfma_f32_16x16x32_bf16 v[28:31], v[44:47], v[36:39], v[28:31]
    s_waitcnt lgkmcnt(6)
    v_mfma_f32_16x16x32_bf16 v[16:19], v[56:59], v[48:51], v[16:19]
    v_add_u32 v10, 12288, v10
    v_add_u32 v11, 12288, v11
    v_add_u32 v12, 12288, v12
    v_add_u32 v14, 12288, v14
    v_add_u32 v15, 12288, v15
    s_barrier
    v_mfma_f32_16x16x32_bf16 v[20:23], v[56:59], v[52:55], v[20:23]
    ds_read_b128 v[32:35], v10 offset:0
    ds_read_b128 v[36:39], v10 offset:3072
    v_mfma_f32_16x16x32_bf16 v[24:27], v[60:63], v[48:51], v[24:27]
    ds_read_b64_tr_b16 v[40:41], v14 offset:0
    ds_read_b64_tr_b16 v[42:43], v14 offset:512
    v_mfma_f32_16x16x32_bf16 v[28:31], v[60:63], v[52:55], v[28:31]
    ds_read_b64_tr_b16 v[44:45], v15 offset:0
    ds_read_b64_tr_b16 v[46:47], v15 offset:512
    s_waitcnt lgkmcnt(6)
    v_mfma_f32_16x16x32_bf16 v[16:19], v[72:75], v[64:67], v[16:19]
    ds_read_b128 v[48:51], v11 offset:0
    ds_read_b128 v[52:55], v11 offset:3072
    v_mfma_f32_16x16x32_bf16 v[20:23], v[72:75], v[68:71], v[20:23]
    ds_read_b64_tr_b16 v[56:57], v14 offset:4096
    ds_read_b64_tr_b16 v[58:59], v14 offset:4608
    v_mfma_f32_16x16x32_bf16 v[24:27], v[76:79], v[64:67], v[24:27]
    ds_read_b64_tr_b16 v[60:61], v15 offset:4096
    ds_read_b64_tr_b16 v[62:63], v15 offset:4608
    v_mfma_f32_16x16x32_bf16 v[28:31], v[76:79], v[68:71], v[28:31]
    s_waitcnt lgkmcnt(6)
    v_mfma_f32_16x16x32_bf16 v[16:19], v[40:43], v[32:35], v[16:19]
    ds_read_b128 v[64:67], v12 offset:0
    ds_read_b128 v[68:71], v12 offset:3072
    v_mfma_f32_16x16x32_bf16 v[20:23], v[40:43], v[36:39], v[20:23]
    ds_read_b64_tr_b16 v[72:73], v14 offset:8192
    ds_read_b64_tr_b16 v[74:75], v14 offset:8704
    v_mfma_f32_16x16x32_bf16 v[24:27], v[44:47], v[32:35], v[24:27]
    ds_read_b64_tr_b16 v[76:77], v15 offset:8192
    ds_read_b64_tr_b16 v[78:79], v15 offset:8704
    v_mfma_f32_16x16x32_bf16 v[28:31], v[44:47], v[36:39], v[28:31]
    s_waitcnt lgkmcnt(6)
    v_mfma_f32_16x16x32_bf16 v[16:19], v[56:59], v[48:51], v[16:19]
    v_subrev_u32 v10, 49152, v10
    v_subrev_u32 v11, 49152, v11
    v_subrev_u32 v12, 49152, v12
    v_add_u32 v14, 12288, v14
    v_add_u32 v15, 12288, v15
    s_barrier
    v_mfma_f32_16x16x32_bf16 v[20:23], v[56:59], v[52:55], v[20:23]
    ds_read_b128 v[32:35], v10 offset:0
    ds_read_b128 v[36:39], v10 offset:3072
    v_mfma_f32_16x16x32_bf16 v[24:27], v[60:63], v[48:51], v[24:27]
    ds_read_b64_tr_b16 v[40:41], v14 offset:0
    ds_read_b64_tr_b16 v[42:43], v14 offset:512
    v_mfma_f32_16x16x32_bf16 v[28:31], v[60:63], v[52:55], v[28:31]
    ds_read_b64_tr_b16 v[44:45], v15 offset:0
    ds_read_b64_tr_b16 v[46:47], v15 offset:512
    s_waitcnt lgkmcnt(6)
    v_mfma_f32_16x16x32_bf16 v[16:19], v[72:75], v[64:67], v[16:19]
    ds_read_b128 v[48:51], v11 offset:0
    ds_read_b128 v[52:55], v11 offset:3072
    v_mfma_f32_16x16x32_bf16 v[20:23], v[72:75], v[68:71], v[20:23]
    ds_read_b64_tr_b16 v[56:57], v14 offset:4096
    ds_read_b64_tr_b16 v[58:59], v14 offset:4608
    v_mfma_f32_16x16x32_bf16 v[24:27], v[76:79], v[64:67], v[24:27]
    ds_read_b64_tr_b16 v[60:61], v15 offset:4096
    ds_read_b64_tr_b16 v[62:63], v15 offset:4608
    v_mfma_f32_16x16x32_bf16 v[28:31], v[76:79], v[68:71], v[28:31]
    s_waitcnt lgkmcnt(6)
    v_mfma_f32_16x16x32_bf16 v[16:19], v[40:43], v[32:35], v[16:19]
    ds_read_b128 v[64:67], v12 offset:0
    ds_read_b128 v[68:71], v12 offset:3072
    v_mfma_f32_16x16x32_bf16 v[20:23], v[40:43], v[36:39], v[20:23]
    ds_read_b64_tr_b16 v[72:73], v14 offset:8192
    ds_read_b64_tr_b16 v[74:75], v14 offset:8704
    v_mfma_f32_16x16x32_bf16 v[24:27], v[44:47], v[32:35], v[24:27]
    ds_read_b64_tr_b16 v[76:77], v15 offset:8192
    ds_read_b64_tr_b16 v[78:79], v15 offset:8704
    v_mfma_f32_16x16x32_bf16 v[28:31], v[44:47], v[36:39], v[28:31]
    s_waitcnt lgkmcnt(6)
    v_mfma_f32_16x16x32_bf16 v[16:19], v[56:59], v[48:51], v[16:19]
    v_add_u32 v10, 12288, v10
    v_add_u32 v11, 12288, v11
    v_add_u32 v12, 12288, v12
    v_add_u32 v14, 12288, v14
    v_add_u32 v15, 12288, v15
    s_barrier
    v_mfma_f32_16x16x32_bf16 v[20:23], v[56:59], v[52:55], v[20:23]
    ds_read_b128 v[32:35], v10 offset:0
    ds_read_b128 v[36:39], v10 offset:3072
    v_mfma_f32_16x16x32_bf16 v[24:27], v[60:63], v[48:51], v[24:27]
    ds_read_b64_tr_b16 v[40:41], v14 offset:0
    ds_read_b64_tr_b16 v[42:43], v14 offset:512
    v_mfma_f32_16x16x32_bf16 v[28:31], v[60:63], v[52:55], v[28:31]
    ds_read_b64_tr_b16 v[44:45], v15 offset:0
    ds_read_b64_tr_b16 v[46:47], v15 offset:512
    s_waitcnt lgkmcnt(6)
    v_mfma_f32_16x16x32_bf16 v[16:19], v[72:75], v[64:67], v[16:19]
    ds_read_b128 v[48:51], v11 offset:0
    ds_read_b128 v[52:55], v11 offset:3072
    v_mfma_f32_16x16x32_bf16 v[20:23], v[72:75], v[68:71], v[20:23]
    ds_read_b64_tr_b16 v[56:57], v14 offset:4096
    ds_read_b64_tr_b16 v[58:59], v14 offset:4608
    v_mfma_f32_16x16x32_bf16 v[24:27], v[76:79], v[64:67], v[24:27]
    ds_read_b64_tr_b16 v[60:61], v15 offset:4096
    ds_read_b64_tr_b16 v[62:63], v15 offset:4608
    v_mfma_f32_16x16x32_bf16 v[28:31], v[76:79], v[68:71], v[28:31]
    s_waitcnt lgkmcnt(6)
    v_mfma_f32_16x16x32_bf16 v[16:19], v[40:43], v[32:35], v[16:19]
    ds_read_b128 v[64:67], v12 offset:0
    ds_read_b128 v[68:71], v12 offset:3072
    v_mfma_f32_16x16x32_bf16 v[20:23], v[40:43], v[36:39], v[20:23]
    ds_read_b64_tr_b16 v[72:73], v14 offset:8192
    ds_read_b64_tr_b16 v[74:75], v14 offset:8704
    v_mfma_f32_16x16x32_bf16 v[24:27], v[44:47], v[32:35], v[24:27]
    ds_read_b64_tr_b16 v[76:77], v15 offset:8192
    ds_read_b64_tr_b16 v[78:79], v15 offset:8704
    v_mfma_f32_16x16x32_bf16 v[28:31], v[44:47], v[36:39], v[28:31]
    s_waitcnt lgkmcnt(6)
    v_mfma_f32_16x16x32_bf16 v[16:19], v[56:59], v[48:51], v[16:19]
    v_add_u32 v10, 12288, v10
    v_add_u32 v11, 12288, v11
    v_add_u32 v12, 12288, v12
    v_add_u32 v14, 12288, v14
    v_add_u32 v15, 12288, v15
    s_barrier
    v_mfma_f32_16x16x32_bf16 v[20:23], v[56:59], v[52:55], v[20:23]
    ds_read_b128 v[32:35], v10 offset:0
    ds_read_b128 v[36:39], v10 offset:3072
    v_mfma_f32_16x16x32_bf16 v[24:27], v[60:63], v[48:51], v[24:27]
    ds_read_b64_tr_b16 v[40:41], v14 offset:0
    ds_read_b64_tr_b16 v[42:43], v14 offset:512
    v_mfma_f32_16x16x32_bf16 v[28:31], v[60:63], v[52:55], v[28:31]
    ds_read_b64_tr_b16 v[44:45], v15 offset:0
    ds_read_b64_tr_b16 v[46:47], v15 offset:512
    s_waitcnt lgkmcnt(6)
    v_mfma_f32_16x16x32_bf16 v[16:19], v[72:75], v[64:67], v[16:19]
    ds_read_b128 v[48:51], v11 offset:0
    ds_read_b128 v[52:55], v11 offset:3072
    v_mfma_f32_16x16x32_bf16 v[20:23], v[72:75], v[68:71], v[20:23]
    ds_read_b64_tr_b16 v[56:57], v14 offset:4096
    ds_read_b64_tr_b16 v[58:59], v14 offset:4608
    v_mfma_f32_16x16x32_bf16 v[24:27], v[76:79], v[64:67], v[24:27]
    ds_read_b64_tr_b16 v[60:61], v15 offset:4096
    ds_read_b64_tr_b16 v[62:63], v15 offset:4608
    v_mfma_f32_16x16x32_bf16 v[28:31], v[76:79], v[68:71], v[28:31]
    s_waitcnt lgkmcnt(6)
    v_mfma_f32_16x16x32_bf16 v[16:19], v[40:43], v[32:35], v[16:19]
    ds_read_b128 v[64:67], v12 offset:0
    ds_read_b128 v[68:71], v12 offset:3072
    v_mfma_f32_16x16x32_bf16 v[20:23], v[40:43], v[36:39], v[20:23]
    ds_read_b64_tr_b16 v[72:73], v14 offset:8192
    ds_read_b64_tr_b16 v[74:75], v14 offset:8704
    v_mfma_f32_16x16x32_bf16 v[24:27], v[44:47], v[32:35], v[24:27]
    ds_read_b64_tr_b16 v[76:77], v15 offset:8192
    ds_read_b64_tr_b16 v[78:79], v15 offset:8704
    v_mfma_f32_16x16x32_bf16 v[28:31], v[44:47], v[36:39], v[28:31]
    s_waitcnt lgkmcnt(6)
    v_mfma_f32_16x16x32_bf16 v[16:19], v[56:59], v[48:51], v[16:19]
    v_add_u32 v10, 12288, v10
    v_add_u32 v11, 12288, v11
    v_add_u32 v12, 12288, v12
    v_add_u32 v14, 12288, v14
    v_add_u32 v15, 12288, v15
    s_barrier
    v_mfma_f32_16x16x32_bf16 v[20:23], v[56:59], v[52:55], v[20:23]
    ds_read_b128 v[32:35], v10 offset:0
    ds_read_b128 v[36:39], v10 offset:3072
    v_mfma_f32_16x16x32_bf16 v[24:27], v[60:63], v[48:51], v[24:27]
    ds_read_b64_tr_b16 v[40:41], v14 offset:0
    ds_read_b64_tr_b16 v[42:43], v14 offset:512
    v_mfma_f32_16x16x32_bf16 v[28:31], v[60:63], v[52:55], v[28:31]
    ds_read_b64_tr_b16 v[44:45], v15 offset:0
    ds_read_b64_tr_b16 v[46:47], v15 offset:512
    s_waitcnt lgkmcnt(6)
    v_mfma_f32_16x16x32_bf16 v[16:19], v[72:75], v[64:67], v[16:19]
    ds_read_b128 v[48:51], v11 offset:0
    ds_read_b128 v[52:55], v11 offset:3072
    v_mfma_f32_16x16x32_bf16 v[20:23], v[72:75], v[68:71], v[20:23]
    ds_read_b64_tr_b16 v[56:57], v14 offset:4096
    ds_read_b64_tr_b16 v[58:59], v14 offset:4608
    v_mfma_f32_16x16x32_bf16 v[24:27], v[76:79], v[64:67], v[24:27]
    ds_read_b64_tr_b16 v[60:61], v15 offset:4096
    ds_read_b64_tr_b16 v[62:63], v15 offset:4608
    v_mfma_f32_16x16x32_bf16 v[28:31], v[76:79], v[68:71], v[28:31]
    s_waitcnt lgkmcnt(6)
    v_mfma_f32_16x16x32_bf16 v[16:19], v[40:43], v[32:35], v[16:19]
    ds_read_b128 v[64:67], v12 offset:0
    ds_read_b128 v[68:71], v12 offset:3072
    v_mfma_f32_16x16x32_bf16 v[20:23], v[40:43], v[36:39], v[20:23]
    ds_read_b64_tr_b16 v[72:73], v14 offset:8192
    ds_read_b64_tr_b16 v[74:75], v14 offset:8704
    v_mfma_f32_16x16x32_bf16 v[24:27], v[44:47], v[32:35], v[24:27]
    ds_read_b64_tr_b16 v[76:77], v15 offset:8192
    ds_read_b64_tr_b16 v[78:79], v15 offset:8704
    v_mfma_f32_16x16x32_bf16 v[28:31], v[44:47], v[36:39], v[28:31]
    s_waitcnt lgkmcnt(6)
    v_mfma_f32_16x16x32_bf16 v[16:19], v[56:59], v[48:51], v[16:19]
    v_add_u32 v10, 12288, v10
    v_add_u32 v11, 12288, v11
    v_add_u32 v12, 12288, v12
    v_subrev_u32 v14, 73728, v14
    v_subrev_u32 v15, 73728, v15
    s_barrier
    v_mfma_f32_16x16x32_bf16 v[20:23], v[56:59], v[52:55], v[20:23]
    ds_read_b128 v[32:35], v10 offset:0
    ds_read_b128 v[36:39], v10 offset:3072
    v_mfma_f32_16x16x32_bf16 v[24:27], v[60:63], v[48:51], v[24:27]
    ds_read_b64_tr_b16 v[40:41], v14 offset:0
    ds_read_b64_tr_b16 v[42:43], v14 offset:512
    v_mfma_f32_16x16x32_bf16 v[28:31], v[60:63], v[52:55], v[28:31]
    ds_read_b64_tr_b16 v[44:45], v15 offset:0
    ds_read_b64_tr_b16 v[46:47], v15 offset:512
    s_waitcnt lgkmcnt(6)
    v_mfma_f32_16x16x32_bf16 v[16:19], v[72:75], v[64:67], v[16:19]
    ds_read_b128 v[48:51], v11 offset:0
    ds_read_b128 v[52:55], v11 offset:3072
    v_mfma_f32_16x16x32_bf16 v[20:23], v[72:75], v[68:71], v[20:23]
    ds_read_b64_tr_b16 v[56:57], v14 offset:4096
    ds_read_b64_tr_b16 v[58:59], v14 offset:4608
    v_mfma_f32_16x16x32_bf16 v[24:27], v[76:79], v[64:67], v[24:27]
    ds_read_b64_tr_b16 v[60:61], v15 offset:4096
    ds_read_b64_tr_b16 v[62:63], v15 offset:4608
    v_mfma_f32_16x16x32_bf16 v[28:31], v[76:79], v[68:71], v[28:31]
    s_waitcnt lgkmcnt(6)
    v_mfma_f32_16x16x32_bf16 v[16:19], v[40:43], v[32:35], v[16:19]
    ds_read_b128 v[64:67], v12 offset:0
    ds_read_b128 v[68:71], v12 offset:3072
    v_mfma_f32_16x16x32_bf16 v[20:23], v[40:43], v[36:39], v[20:23]
    ds_read_b64_tr_b16 v[72:73], v14 offset:8192
    ds_read_b64_tr_b16 v[74:75], v14 offset:8704
    v_mfma_f32_16x16x32_bf16 v[24:27], v[44:47], v[32:35], v[24:27]
    ds_read_b64_tr_b16 v[76:77], v15 offset:8192
    ds_read_b64_tr_b16 v[78:79], v15 offset:8704
    v_mfma_f32_16x16x32_bf16 v[28:31], v[44:47], v[36:39], v[28:31]
    s_waitcnt lgkmcnt(6)
    v_mfma_f32_16x16x32_bf16 v[16:19], v[56:59], v[48:51], v[16:19]
    v_subrev_u32 v10, 49152, v10
    v_subrev_u32 v11, 49152, v11
    v_subrev_u32 v12, 49152, v12
    v_add_u32 v14, 12288, v14
    v_add_u32 v15, 12288, v15
    s_barrier
    v_mfma_f32_16x16x32_bf16 v[20:23], v[56:59], v[52:55], v[20:23]
    ds_read_b128 v[32:35], v10 offset:0
    ds_read_b128 v[36:39], v10 offset:3072
    v_mfma_f32_16x16x32_bf16 v[24:27], v[60:63], v[48:51], v[24:27]
    ds_read_b64_tr_b16 v[40:41], v14 offset:0
    ds_read_b64_tr_b16 v[42:43], v14 offset:512
    v_mfma_f32_16x16x32_bf16 v[28:31], v[60:63], v[52:55], v[28:31]
    ds_read_b64_tr_b16 v[44:45], v15 offset:0
    ds_read_b64_tr_b16 v[46:47], v15 offset:512
    s_waitcnt lgkmcnt(6)
    v_mfma_f32_16x16x32_bf16 v[16:19], v[72:75], v[64:67], v[16:19]
    ds_read_b128 v[48:51], v11 offset:0
    ds_read_b128 v[52:55], v11 offset:3072
    v_mfma_f32_16x16x32_bf16 v[20:23], v[72:75], v[68:71], v[20:23]
    ds_read_b64_tr_b16 v[56:57], v14 offset:4096
    ds_read_b64_tr_b16 v[58:59], v14 offset:4608
    v_mfma_f32_16x16x32_bf16 v[24:27], v[76:79], v[64:67], v[24:27]
    ds_read_b64_tr_b16 v[60:61], v15 offset:4096
    ds_read_b64_tr_b16 v[62:63], v15 offset:4608
    v_mfma_f32_16x16x32_bf16 v[28:31], v[76:79], v[68:71], v[28:31]
    s_waitcnt lgkmcnt(6)
    v_mfma_f32_16x16x32_bf16 v[16:19], v[40:43], v[32:35], v[16:19]
    ds_read_b128 v[64:67], v12 offset:0
    ds_read_b128 v[68:71], v12 offset:3072
    v_mfma_f32_16x16x32_bf16 v[20:23], v[40:43], v[36:39], v[20:23]
    ds_read_b64_tr_b16 v[72:73], v14 offset:8192
    ds_read_b64_tr_b16 v[74:75], v14 offset:8704
    v_mfma_f32_16x16x32_bf16 v[24:27], v[44:47], v[32:35], v[24:27]
    ds_read_b64_tr_b16 v[76:77], v15 offset:8192
    ds_read_b64_tr_b16 v[78:79], v15 offset:8704
    v_mfma_f32_16x16x32_bf16 v[28:31], v[44:47], v[36:39], v[28:31]
    s_waitcnt lgkmcnt(6)
    v_mfma_f32_16x16x32_bf16 v[16:19], v[56:59], v[48:51], v[16:19]
    v_mfma_f32_16x16x32_bf16 v[20:23], v[56:59], v[52:55], v[20:23]
    v_mfma_f32_16x16x32_bf16 v[24:27], v[60:63], v[48:51], v[24:27]
    v_mfma_f32_16x16x32_bf16 v[28:31], v[60:63], v[52:55], v[28:31]
    s_waitcnt lgkmcnt(0)
    v_mfma_f32_16x16x32_bf16 v[16:19], v[72:75], v[64:67], v[16:19]
    v_mfma_f32_16x16x32_bf16 v[20:23], v[72:75], v[68:71], v[20:23]
    v_mfma_f32_16x16x32_bf16 v[24:27], v[76:79], v[64:67], v[24:27]
    v_mfma_f32_16x16x32_bf16 v[28:31], v[76:79], v[68:71], v[28:31]
    v_lshrrev_b32 v7, 1, v5
    v_lshl_add_u32 v7, v4, 1, v7
    v_and_b32 v7, 3, v7
    v_lshl_add_u32 v8, v4, 2, v5
    s_lshl_b32 s52, s51, 5
    v_add_u32 v8, s52, v8
    s_lshl_b32 s52, s50, 1
    s_add_u32 s52, s52, 0
    v_xor_b32 v9, s52, v7
    v_lshlrev_b32 v9, 5, v9
    v_lshl_add_u32 v9, v6, 3, v9
    v_lshl_add_u32 v9, v8, 7, v9
    v_add_u32 v10, 0x10000, v9
    s_lshl_b32 s52, s50, 1
    s_add_u32 s52, s52, 1
    v_xor_b32 v9, s52, v7
    v_lshlrev_b32 v9, 5, v9
    v_lshl_add_u32 v9, v6, 3, v9
    v_lshl_add_u32 v9, v8, 7, v9
    v_add_u32 v11, 0x10000, v9
    ds_read_b64_tr_b16 v[160:161], v10 offset:0
    ds_read_b64_tr_b16 v[162:163], v11 offset:0
    ds_read_b64_tr_b16 v[164:165], v10 offset:2048
    ds_read_b64_tr_b16 v[166:167], v11 offset:2048
    s_lshl_b32 s52, s50, 5
    s_add_u32 s52, s52, s72
    v_add_u32 v8, s52, v3
    v_lshlrev_b32 v8, 10, v8
    v_lshl_add_u32 v8, v4, 3, v8
    s_lshl_b32 s52, s51, 5
    s_add_u32 s52, s52, s73
    s_lshl_b32 s52, s52, 1
    s_add_u32 s53, s52, 16384
    s_nop 4
    s_waitcnt lgkmcnt(0)
    v_cvt_pk_bf16_f32 v16, v16, v17
    v_lshlrev_b32 v170, 16, v160
    v_and_b32 v171, s60, v160
    v_and_b32 v17, s60, v16
    v_lshlrev_b32 v16, 16, v16
    v_add_f32 v16, v16, v170
    v_add_f32 v17, v17, v171
    v_cvt_pk_bf16_f32 v160, v16, v17
    v_cvt_pk_bf16_f32 v18, v18, v19
    v_lshlrev_b32 v170, 16, v161
    v_and_b32 v171, s60, v161
    v_and_b32 v19, s60, v18
    v_lshlrev_b32 v18, 16, v18
    v_add_f32 v18, v18, v170
    v_add_f32 v19, v19, v171
    v_cvt_pk_bf16_f32 v161, v18, v19
    buffer_store_dwordx2 v[160:161], v8, s[12:15], s52 offen offset:0
    v_cvt_pk_bf16_f32 v20, v20, v21
    v_lshlrev_b32 v170, 16, v162
    v_and_b32 v171, s60, v162
    v_and_b32 v21, s60, v20
    v_lshlrev_b32 v20, 16, v20
    v_add_f32 v20, v20, v170
    v_add_f32 v21, v21, v171
    v_cvt_pk_bf16_f32 v162, v20, v21
    v_cvt_pk_bf16_f32 v22, v22, v23
    v_lshlrev_b32 v170, 16, v163
    v_and_b32 v171, s60, v163
    v_and_b32 v23, s60, v22
    v_lshlrev_b32 v22, 16, v22
    v_add_f32 v22, v22, v170
    v_add_f32 v23, v23, v171
    v_cvt_pk_bf16_f32 v163, v22, v23
    buffer_store_dwordx2 v[162:163], v8, s[12:15], s53 offen offset:0
    v_cvt_pk_bf16_f32 v24, v24, v25
    v_lshlrev_b32 v170, 16, v164
    v_and_b32 v171, s60, v164
    v_and_b32 v25, s60, v24
    v_lshlrev_b32 v24, 16, v24
    v_add_f32 v24, v24, v170
    v_add_f32 v25, v25, v171
    v_cvt_pk_bf16_f32 v164, v24, v25
    v_cvt_pk_bf16_f32 v26, v26, v27
    v_lshlrev_b32 v170, 16, v165
    v_and_b32 v171, s60, v165
    v_and_b32 v27, s60, v26
    v_lshlrev_b32 v26, 16, v26
    v_add_f32 v26, v26, v170
    v_add_f32 v27, v27, v171
    v_cvt_pk_bf16_f32 v165, v26, v27
    buffer_store_dwordx2 v[164:165], v8, s[12:15], s52 offen offset:32
    v_cvt_pk_bf16_f32 v28, v28, v29
    v_lshlrev_b32 v170, 16, v166
    v_and_b32 v171, s60, v166
    v_and_b32 v29, s60, v28
    v_lshlrev_b32 v28, 16, v28
    v_add_f32 v28, v28, v170
    v_add_f32 v29, v29, v171
    v_cvt_pk_bf16_f32 v166, v28, v29
    v_cvt_pk_bf16_f32 v30, v30, v31
    v_lshlrev_b32 v170, 16, v167
    v_and_b32 v171, s60, v167
    v_and_b32 v31, s60, v30
    v_lshlrev_b32 v30, 16, v30
    v_add_f32 v30, v30, v170
    v_add_f32 v31, v31, v171
    v_cvt_pk_bf16_f32 v167, v30, v31
    buffer_store_dwordx2 v[166:167], v8, s[12:15], s53 offen offset:32
    s_endpgm
M_LOADER:
    v_lshrrev_b32 v5, 4, v1
    v_add_u32 v6, 0, v5
    v_lshlrev_b32 v6, 1, v6
    v_xor_b32 v6, v6, v3
    v_lshlrev_b32 v6, 4, v6
    v_lshl_add_u32 v10, v5, 12, v6
    v_add_u32 v6, 4, v5
    v_lshlrev_b32 v6, 1, v6
    v_xor_b32 v6, v6, v3
    v_lshlrev_b32 v6, 4, v6
    v_lshl_add_u32 v11, v5, 12, v6
    s_lshl_b32 s52, s88, 16
    s_lshl_b32 s53, s47, 1
    s_add_u32 s52, s52, s53
    s_add_u32 s52, s52, 0x400000
    s_lshl_b32 s54, s88, 12
    s_add_u32 m0, s54, 0
    s_add_u32 s56, s52, 0
    buffer_load_dwordx4 v10, s[8:11], s56 offen sc1 lds
    s_add_u32 m0, s54, 1024
    s_add_u32 s56, s52, 16384
    buffer_load_dwordx4 v11, s[8:11], s56 offen sc1 lds
    s_add_u32 m0, s54, 2048
    s_add_u32 s56, s52, 32768
    buffer_load_dwordx4 v10, s[8:11], s56 offen sc1 lds
    s_add_u32 m0, s54, 3072
    s_add_u32 s56, s52, 49152
    buffer_load_dwordx4 v11, s[8:11], s56 offen sc1 lds
    s_add_u32 m0, s54, 16384
    s_add_u32 s56, s52, 262144
    buffer_load_dwordx4 v10, s[8:11], s56 offen sc1 lds
    s_add_u32 m0, s54, 17408
    s_add_u32 s56, s52, 278528
    buffer_load_dwordx4 v11, s[8:11], s56 offen sc1 lds
    s_add_u32 m0, s54, 18432
    s_add_u32 s56, s52, 294912
    buffer_load_dwordx4 v10, s[8:11], s56 offen sc1 lds
    s_add_u32 m0, s54, 19456
    s_add_u32 s56, s52, 311296
    buffer_load_dwordx4 v11, s[8:11], s56 offen sc1 lds
    s_add_u32 m0, s54, 32768
    s_add_u32 s56, s52, 524288
    buffer_load_dwordx4 v10, s[8:11], s56 offen sc1 lds
    s_add_u32 m0, s54, 33792
    s_add_u32 s56, s52, 540672
    buffer_load_dwordx4 v11, s[8:11], s56 offen sc1 lds
    s_add_u32 m0, s54, 34816
    s_add_u32 s56, s52, 557056
    buffer_load_dwordx4 v10, s[8:11], s56 offen sc1 lds
    s_add_u32 m0, s54, 35840
    s_add_u32 s56, s52, 573440
    buffer_load_dwordx4 v11, s[8:11], s56 offen sc1 lds
    s_add_u32 m0, s54, 49152
    s_add_u32 s56, s52, 786432
    buffer_load_dwordx4 v10, s[8:11], s56 offen sc1 lds
    s_add_u32 m0, s54, 50176
    s_add_u32 s56, s52, 802816
    buffer_load_dwordx4 v11, s[8:11], s56 offen sc1 lds
    s_add_u32 m0, s54, 51200
    s_add_u32 s56, s52, 819200
    buffer_load_dwordx4 v10, s[8:11], s56 offen sc1 lds
    s_add_u32 m0, s54, 52224
    s_add_u32 s56, s52, 835584
    buffer_load_dwordx4 v11, s[8:11], s56 offen sc1 lds
    s_mov_b32 s4, s36
    s_and_b32 s5, s37, 0xffff
    s_mov_b32 s6, 0x158000
    s_mov_b32 s7, 0x00020000
    v_lshrrev_b32 v6, 3, v1
    v_and_b32 v7, 7, v1
    v_lshlrev_b32 v20, 4, v1
    s_add_u32 s61, s88, 0
    s_and_b32 s61, s61, 1
    s_lshl_b32 s61, s61, 1
    v_and_b32 v8, 1, v5
    v_or_b32 v8, s61, v8
    v_lshlrev_b32 v8, 1, v8
    v_xor_b32 v8, v8, v7
    v_lshlrev_b32 v8, 4, v8
    v_lshl_add_u32 v21, v6, 10, v8
    s_add_u32 s61, s88, 1
    s_and_b32 s61, s61, 1
    s_lshl_b32 s61, s61, 1
    v_and_b32 v8, 1, v5
    v_or_b32 v8, s61, v8
    v_lshlrev_b32 v8, 1, v8
    v_xor_b32 v8, v8, v7
    v_lshlrev_b32 v8, 4, v8
    v_lshl_add_u32 v22, v6, 10, v8
    s_add_u32 s61, s88, 2
    s_and_b32 s61, s61, 1
    s_lshl_b32 s61, s61, 1
    v_and_b32 v8, 1, v5
    v_or_b32 v8, s61, v8
    v_lshlrev_b32 v8, 1, v8
    v_xor_b32 v8, v8, v7
    v_lshlrev_b32 v8, 4, v8
    v_lshl_add_u32 v23, v6, 10, v8
    v_lshlrev_b32 v8, 1, v5
    v_xor_b32 v8, v8, v7
    v_lshlrev_b32 v8, 4, v8
    v_lshl_add_u32 v26, v6, 12, v8
    s_and_b32 s61, s45, 0xf0
    s_mul_i32 s61, s61, 24576
    s_bfe_u32 s62, s45, 0x10003
    s_mul_i32 s62, s62, 12288
    s_add_u32 s61, s61, s62
    s_mul_i32 s65, s88, 3072
    s_add_u32 s61, s61, s65
    s_add_u32 s61, s61, 0x600000
    s_mul_i32 s62, s88, 24576
    s_lshl_b32 s63, s73, 1
    s_add_u32 s62, s62, s63
    s_lshl_b32 s63, s88, 4
    s_add_u32 s63, s63, s73
    s_lshl_b32 s63, s63, 12
    s_lshl_b32 s64, s72, 1
    s_add_u32 s63, s63, s64
    s_add_u32 s63, s63, 0x400000
    s_lshl_b32 s64, s88, 11
    s_waitcnt vmcnt(12)
    s_barrier
    s_waitcnt vmcnt(8)
    s_barrier
    s_and_b32 s96, s2, 7
    s_lshl_b32 s96, s96, 7
    s_add_u32 s96, s96, 0xc11800
    v_and_b32 v252, 3, v1
    v_lshl_add_u32 v252, v252, 10, s96
    s_mov_b32 s96, 32
    s_mov_b32 s97, 0
POLL_44:
    buffer_load_dword v253, v252, s[8:11], 0 offen sc1
    s_waitcnt vmcnt(0)
    v_cmp_ne_u32 vcc, s96, v253
    s_add_u32 s97, s97, 1
    s_nop 3
    s_cmp_eq_u64 vcc, 0
    s_cbranch_scc1 POLLE_45
    s_cmp_gt_u32 s97, 0x200000
    s_cbranch_scc1 POLLE_45
    s_sleep 1
    s_branch POLL_44
POLLE_45:
    s_add_u32 m0, s54, 0
    s_add_u32 s56, s52, 1048576
    buffer_load_dwordx4 v10, s[8:11], s56 offen sc1 lds
    s_add_u32 m0, s54, 1024
    s_add_u32 s56, s52, 1064960
    buffer_load_dwordx4 v11, s[8:11], s56 offen sc1 lds
    s_add_u32 m0, s54, 2048
    s_add_u32 s56, s52, 1081344
    buffer_load_dwordx4 v10, s[8:11], s56 offen sc1 lds
    s_add_u32 m0, s54, 3072
    s_add_u32 s56, s52, 1097728
    buffer_load_dwordx4 v11, s[8:11], s56 offen sc1 lds
    s_add_u32 s56, s89, 704512
    s_add_u32 m0, s90, 65536
    s_nop 0
    buffer_load_dwordx4 v244, s[80:83], s56 offen lds
    s_add_u32 m0, s90, 66560
    s_nop 0
    buffer_load_dwordx4 v245, s[80:83], s56 offen lds
    s_add_u32 m0, s90, 67584
    s_nop 0
    buffer_load_dwordx4 v246, s[80:83], s56 offen lds
    s_add_u32 m0, s90, 77824
    s_nop 0
    buffer_load_dwordx4 v244, s[84:87], s56 offen lds
    s_add_u32 m0, s90, 78848
    s_nop 0
    buffer_load_dwordx4 v245, s[84:87], s56 offen lds
    s_add_u32 m0, s90, 79872
    s_nop 0
    buffer_load_dwordx4 v246, s[84:87], s56 offen lds
    s_waitcnt vmcnt(10)
    s_barrier
    s_add_u32 m0, s54, 16384
    s_add_u32 s56, s52, 1310720
    buffer_load_dwordx4 v10, s[8:11], s56 offen sc1 lds
    s_add_u32 m0, s54, 17408
    s_add_u32 s56, s52, 1327104
    buffer_load_dwordx4 v11, s[8:11], s56 offen sc1 lds
    s_add_u32 m0, s54, 18432
    s_add_u32 s56, s52, 1343488
    buffer_load_dwordx4 v10, s[8:11], s56 offen sc1 lds
    s_add_u32 m0, s54, 19456
    s_add_u32 s56, s52, 1359872
    buffer_load_dwordx4 v11, s[8:11], s56 offen sc1 lds
    s_add_u32 s56, s89, 880640
    s_add_u32 m0, s90, 90112
    s_nop 0
    buffer_load_dwordx4 v244, s[80:83], s56 offen lds
    s_add_u32 m0, s90, 91136
    s_nop 0
    buffer_load_dwordx4 v245, s[80:83], s56 offen lds
    s_add_u32 m0, s90, 92160
    s_nop 0
    buffer_load_dwordx4 v246, s[80:83], s56 offen lds
    s_add_u32 m0, s90, 102400
    s_nop 0
    buffer_load_dwordx4 v244, s[84:87], s56 offen lds
    s_add_u32 m0, s90, 103424
    s_nop 0
    buffer_load_dwordx4 v245, s[84:87], s56 offen lds
    s_add_u32 m0, s90, 104448
    s_nop 0
    buffer_load_dwordx4 v246, s[84:87], s56 offen lds
    s_waitcnt vmcnt(20)
    s_barrier
    s_add_u32 m0, s54, 32768
    s_add_u32 s56, s52, 1572864
    buffer_load_dwordx4 v10, s[8:11], s56 offen sc1 lds
    s_add_u32 m0, s54, 33792
    s_add_u32 s56, s52, 1589248
    buffer_load_dwordx4 v11, s[8:11], s56 offen sc1 lds
    s_add_u32 m0, s54, 34816
    s_add_u32 s56, s52, 1605632
    buffer_load_dwordx4 v10, s[8:11], s56 offen sc1 lds
    s_add_u32 m0, s54, 35840
    s_add_u32 s56, s52, 1622016
    buffer_load_dwordx4 v11, s[8:11], s56 offen sc1 lds
    s_add_u32 s56, s89, 1056768
    s_add_u32 m0, s90, 114688
    s_nop 0
    buffer_load_dwordx4 v244, s[80:83], s56 offen lds
    s_add_u32 m0, s90, 115712
    s_nop 0
    buffer_load_dwordx4 v245, s[80:83], s56 offen lds
    s_add_u32 m0, s90, 116736
    s_nop 0
    buffer_load_dwordx4 v246, s[80:83], s56 offen lds
    s_add_u32 m0, s90, 126976
    s_nop 0
    buffer_load_dwordx4 v244, s[84:87], s56 offen lds
    s_add_u32 m0, s90, 128000
    s_nop 0
    buffer_load_dwordx4 v245, s[84:87], s56 offen lds
    s_add_u32 m0, s90, 129024
    s_nop 0
    buffer_load_dwordx4 v246, s[84:87], s56 offen lds
    s_waitcnt vmcnt(20)
    s_barrier
    s_add_u32 m0, s54, 49152
    s_add_u32 s56, s52, 1835008
    buffer_load_dwordx4 v10, s[8:11], s56 offen sc1 lds
    s_add_u32 m0, s54, 50176
    s_add_u32 s56, s52, 1851392
    buffer_load_dwordx4 v11, s[8:11], s56 offen sc1 lds
    s_add_u32 m0, s54, 51200
    s_add_u32 s56, s52, 1867776
    buffer_load_dwordx4 v10, s[8:11], s56 offen sc1 lds
    s_add_u32 m0, s54, 52224
    s_add_u32 s56, s52, 1884160
    buffer_load_dwordx4 v11, s[8:11], s56 offen sc1 lds
    s_add_u32 s56, s89, 1232896
    s_add_u32 m0, s90, 139264
    s_nop 0
    buffer_load_dwordx4 v244, s[80:83], s56 offen lds
    s_add_u32 m0, s90, 140288
    s_nop 0
    buffer_load_dwordx4 v245, s[80:83], s56 offen lds
    s_add_u32 m0, s90, 141312
    s_nop 0
    buffer_load_dwordx4 v246, s[80:83], s56 offen lds
    s_add_u32 m0, s90, 151552
    s_nop 0
    buffer_load_dwordx4 v244, s[84:87], s56 offen lds
    s_add_u32 m0, s90, 152576
    s_nop 0
    buffer_load_dwordx4 v245, s[84:87], s56 offen lds
    s_add_u32 m0, s90, 153600
    s_nop 0
    buffer_load_dwordx4 v246, s[84:87], s56 offen lds
    s_waitcnt vmcnt(20)
    s_barrier
    s_waitcnt vmcnt(10)
    s_barrier
    s_waitcnt vmcnt(0)
    s_barrier
    s_barrier
    s_add_u32 m0, s65, 73728
    s_add_u32 s57, s62, 0
    buffer_load_dwordx4 v21, s[4:7], s57 offen lds
    s_add_u32 m0, s65, 74752
    s_add_u32 s57, s62, 8192
    buffer_load_dwordx4 v22, s[4:7], s57 offen lds
    s_add_u32 m0, s65, 75776
    s_add_u32 s57, s62, 16384
    buffer_load_dwordx4 v23, s[4:7], s57 offen lds
    s_add_u32 m0, s65, 86016
    s_add_u32 s57, s62, 81920
    buffer_load_dwordx4 v21, s[4:7], s57 offen lds
    s_add_u32 m0, s65, 87040
    s_add_u32 s57, s62, 90112
    buffer_load_dwordx4 v22, s[4:7], s57 offen lds
    s_add_u32 m0, s65, 88064
    s_add_u32 s57, s62, 98304
    buffer_load_dwordx4 v23, s[4:7], s57 offen lds
    s_add_u32 m0, s65, 98304
    s_add_u32 s57, s62, 180224
    buffer_load_dwordx4 v21, s[4:7], s57 offen lds
    s_add_u32 m0, s65, 99328
    s_add_u32 s57, s62, 188416
    buffer_load_dwordx4 v22, s[4:7], s57 offen lds
    s_add_u32 m0, s65, 100352
    s_add_u32 s57, s62, 196608
    buffer_load_dwordx4 v23, s[4:7], s57 offen lds
    s_add_u32 m0, s65, 110592
    s_add_u32 s57, s62, 262144
    buffer_load_dwordx4 v21, s[4:7], s57 offen lds
    s_add_u32 m0, s65, 111616
    s_add_u32 s57, s62, 270336
    buffer_load_dwordx4 v22, s[4:7], s57 offen lds
    s_add_u32 m0, s65, 112640
    s_add_u32 s57, s62, 278528
    buffer_load_dwordx4 v23, s[4:7], s57 offen lds
    s_add_u32 m0, s64, 65536
    s_add_u32 s57, s63, 0
    buffer_load_dwordx4 v26, s[8:11], s57 offen sc1 lds
    s_add_u32 m0, s64, 66560
    s_add_u32 s57, s63, 32768
    buffer_load_dwordx4 v26, s[8:11], s57 offen sc1 lds
    s_barrier
    s_add_u32 m0, s65, 122880
    s_add_u32 s57, s62, 360448
    buffer_load_dwordx4 v21, s[4:7], s57 offen lds
    s_add_u32 m0, s65, 123904
    s_add_u32 s57, s62, 368640
    buffer_load_dwordx4 v22, s[4:7], s57 offen lds
    s_add_u32 m0, s65, 124928
    s_add_u32 s57, s62, 376832
    buffer_load_dwordx4 v23, s[4:7], s57 offen lds
    s_add_u32 m0, s65, 135168
    s_add_u32 s57, s62, 442368
    buffer_load_dwordx4 v21, s[4:7], s57 offen lds
    s_add_u32 m0, s65, 136192
    s_add_u32 s57, s62, 450560
    buffer_load_dwordx4 v22, s[4:7], s57 offen lds
    s_add_u32 m0, s65, 137216
    s_add_u32 s57, s62, 458752
    buffer_load_dwordx4 v23, s[4:7], s57 offen lds
    s_add_u32 m0, s65, 147456
    s_add_u32 s57, s62, 524288
    buffer_load_dwordx4 v21, s[4:7], s57 offen lds
    s_add_u32 m0, s65, 148480
    s_add_u32 s57, s62, 532480
    buffer_load_dwordx4 v22, s[4:7], s57 offen lds
    s_add_u32 m0, s65, 149504
    s_add_u32 s57, s62, 540672
    buffer_load_dwordx4 v23, s[4:7], s57 offen lds
    s_barrier
    s_barrier
    s_add_u32 m0, s65, 0
    s_add_u32 s57, s61, 0
    buffer_load_dwordx4 v20, s[8:11], s57 offen offset:0 sc1 lds
    buffer_load_dwordx4 v20, s[8:11], s57 offen offset:1024 sc1 lds
    buffer_load_dwordx4 v20, s[8:11], s57 offen offset:2048 sc1 lds
    s_add_u32 m0, s65, 12288
    s_add_u32 s57, s61, 24576
    buffer_load_dwordx4 v20, s[8:11], s57 offen offset:0 sc1 lds
    buffer_load_dwordx4 v20, s[8:11], s57 offen offset:1024 sc1 lds
    buffer_load_dwordx4 v20, s[8:11], s57 offen offset:2048 sc1 lds
    s_add_u32 m0, s65, 24576
    s_add_u32 s57, s61, 49152
    buffer_load_dwordx4 v20, s[8:11], s57 offen offset:0 sc1 lds
    buffer_load_dwordx4 v20, s[8:11], s57 offen offset:1024 sc1 lds
    buffer_load_dwordx4 v20, s[8:11], s57 offen offset:2048 sc1 lds
    s_add_u32 m0, s65, 36864
    s_add_u32 s57, s61, 73728
    buffer_load_dwordx4 v20, s[8:11], s57 offen offset:0 sc1 lds
    buffer_load_dwordx4 v20, s[8:11], s57 offen offset:1024 sc1 lds
    buffer_load_dwordx4 v20, s[8:11], s57 offen offset:2048 sc1 lds
    s_add_u32 m0, s65, 49152
    s_add_u32 s57, s61, 98304
    buffer_load_dwordx4 v20, s[8:11], s57 offen offset:0 sc1 lds
    buffer_load_dwordx4 v20, s[8:11], s57 offen offset:1024 sc1 lds
    buffer_load_dwordx4 v20, s[8:11], s57 offen offset:2048 sc1 lds
    s_waitcnt vmcnt(12)
    s_barrier
    s_waitcnt vmcnt(9)
    s_barrier
    s_waitcnt vmcnt(6)
    s_barrier
    s_add_u32 m0, s65, 73728
    s_add_u32 s57, s62, 622592
    buffer_load_dwordx4 v21, s[4:7], s57 offen lds
    s_add_u32 m0, s65, 74752
    s_add_u32 s57, s62, 630784
    buffer_load_dwordx4 v22, s[4:7], s57 offen lds
    s_add_u32 m0, s65, 75776
    s_add_u32 s57, s62, 638976
    buffer_load_dwordx4 v23, s[4:7], s57 offen lds
    s_add_u32 m0, s65, 0
    s_add_u32 s57, s61, 122880
    buffer_load_dwordx4 v20, s[8:11], s57 offen offset:0 sc1 lds
    buffer_load_dwordx4 v20, s[8:11], s57 offen offset:1024 sc1 lds
    buffer_load_dwordx4 v20, s[8:11], s57 offen offset:2048 sc1 lds
    s_waitcnt vmcnt(9)
    s_barrier
    s_add_u32 m0, s65, 86016
    s_add_u32 s57, s62, 704512
    buffer_load_dwordx4 v21, s[4:7], s57 offen lds
    s_add_u32 m0, s65, 87040
    s_add_u32 s57, s62, 712704
    buffer_load_dwordx4 v22, s[4:7], s57 offen lds
    s_add_u32 m0, s65, 88064
    s_add_u32 s57, s62, 720896
    buffer_load_dwordx4 v23, s[4:7], s57 offen lds
    s_add_u32 m0, s65, 12288
    s_add_u32 s57, s61, 147456
    buffer_load_dwordx4 v20, s[8:11], s57 offen offset:0 sc1 lds
    buffer_load_dwordx4 v20, s[8:11], s57 offen offset:1024 sc1 lds
    buffer_load_dwordx4 v20, s[8:11], s57 offen offset:2048 sc1 lds
    s_waitcnt vmcnt(12)
    s_barrier
    s_add_u32 m0, s65, 98304
    s_add_u32 s57, s62, 786432
    buffer_load_dwordx4 v21, s[4:7], s57 offen lds
    s_add_u32 m0, s65, 99328
    s_add_u32 s57, s62, 794624
    buffer_load_dwordx4 v22, s[4:7], s57 offen lds
    s_add_u32 m0, s65, 100352
    s_add_u32 s57, s62, 802816
    buffer_load_dwordx4 v23, s[4:7], s57 offen lds
    s_add_u32 m0, s65, 24576
    s_add_u32 s57, s61, 172032
    buffer_load_dwordx4 v20, s[8:11], s57 offen offset:0 sc1 lds
    buffer_load_dwordx4 v20, s[8:11], s57 offen offset:1024 sc1 lds
    buffer_load_dwordx4 v20, s[8:11], s57 offen offset:2048 sc1 lds
    s_waitcnt vmcnt(12)
    s_barrier
    s_add_u32 m0, s65, 110592
    s_add_u32 s57, s62, 884736
    buffer_load_dwordx4 v21, s[4:7], s57 offen lds
    s_add_u32 m0, s65, 111616
    s_add_u32 s57, s62, 892928
    buffer_load_dwordx4 v22, s[4:7], s57 offen lds
    s_add_u32 m0, s65, 112640
    s_add_u32 s57, s62, 901120
    buffer_load_dwordx4 v23, s[4:7], s57 offen lds
    s_add_u32 m0, s65, 36864
    s_add_u32 s57, s61, 196608
    buffer_load_dwordx4 v20, s[8:11], s57 offen offset:0 sc1 lds
    buffer_load_dwordx4 v20, s[8:11], s57 offen offset:1024 sc1 lds
    buffer_load_dwordx4 v20, s[8:11], s57 offen offset:2048 sc1 lds
    s_waitcnt vmcnt(12)
    s_barrier
    s_add_u32 m0, s65, 122880
    s_add_u32 s57, s62, 966656
    buffer_load_dwordx4 v21, s[4:7], s57 offen lds
    s_add_u32 m0, s65, 123904
    s_add_u32 s57, s62, 974848
    buffer_load_dwordx4 v22, s[4:7], s57 offen lds
    s_add_u32 m0, s65, 124928
    s_add_u32 s57, s62, 983040
    buffer_load_dwordx4 v23, s[4:7], s57 offen lds
    s_add_u32 m0, s65, 49152
    s_add_u32 s57, s61, 221184
    buffer_load_dwordx4 v20, s[8:11], s57 offen offset:0 sc1 lds
    buffer_load_dwordx4 v20, s[8:11], s57 offen offset:1024 sc1 lds
    buffer_load_dwordx4 v20, s[8:11], s57 offen offset:2048 sc1 lds
    s_waitcnt vmcnt(12)
    s_barrier
    s_add_u32 m0, s65, 135168
    s_add_u32 s57, s62, 1064960
    buffer_load_dwordx4 v21, s[4:7], s57 offen lds
    s_add_u32 m0, s65, 136192
    s_add_u32 s57, s62, 1073152
    buffer_load_dwordx4 v22, s[4:7], s57 offen lds
    s_add_u32 m0, s65, 137216
    s_add_u32 s57, s62, 1081344
    buffer_load_dwordx4 v23, s[4:7], s57 offen lds
    s_add_u32 m0, s65, 0
    s_add_u32 s57, s61, 245760
    buffer_load_dwordx4 v20, s[8:11], s57 offen offset:0 sc1 lds
    buffer_load_dwordx4 v20, s[8:11], s57 offen offset:1024 sc1 lds
    buffer_load_dwordx4 v20, s[8:11], s57 offen offset:2048 sc1 lds
    s_waitcnt vmcnt(12)
    s_barrier
    s_add_u32 m0, s65, 147456
    s_add_u32 s57, s62, 1146880
    buffer_load_dwordx4 v21, s[4:7], s57 offen lds
    s_add_u32 m0, s65, 148480
    s_add_u32 s57, s62, 1155072
    buffer_load_dwordx4 v22, s[4:7], s57 offen lds
    s_add_u32 m0, s65, 149504
    s_add_u32 s57, s62, 1163264
    buffer_load_dwordx4 v23, s[4:7], s57 offen lds
    s_add_u32 m0, s65, 12288
    s_add_u32 s57, s61, 270336
    buffer_load_dwordx4 v20, s[8:11], s57 offen offset:0 sc1 lds
    buffer_load_dwordx4 v20, s[8:11], s57 offen offset:1024 sc1 lds
    buffer_load_dwordx4 v20, s[8:11], s57 offen offset:2048 sc1 lds
    s_waitcnt vmcnt(12)
    s_barrier
    s_add_u32 m0, s65, 73728
    s_add_u32 s57, s62, 1228800
    buffer_load_dwordx4 v21, s[4:7], s57 offen lds
    s_add_u32 m0, s65, 74752
    s_add_u32 s57, s62, 1236992
    buffer_load_dwordx4 v22, s[4:7], s57 offen lds
    s_add_u32 m0, s65, 75776
    s_add_u32 s57, s62, 1245184
    buffer_load_dwordx4 v23, s[4:7], s57 offen lds
    s_add_u32 m0, s65, 24576
    s_add_u32 s57, s61, 294912
    buffer_load_dwordx4 v20, s[8:11], s57 offen offset:0 sc1 lds
    buffer_load_dwordx4 v20, s[8:11], s57 offen offset:1024 sc1 lds
    buffer_load_dwordx4 v20, s[8:11], s57 offen offset:2048 sc1 lds
    s_waitcnt vmcnt(12)
    s_barrier
    s_add_u32 m0, s65, 86016
    s_add_u32 s57, s62, 1310720
    buffer_load_dwordx4 v21, s[4:7], s57 offen lds
    s_add_u32 m0, s65, 87040
    s_add_u32 s57, s62, 1318912
    buffer_load_dwordx4 v22, s[4:7], s57 offen lds
    s_add_u32 m0, s65, 88064
    s_add_u32 s57, s62, 1327104
    buffer_load_dwordx4 v23, s[4:7], s57 offen lds
    s_add_u32 m0, s65, 36864
    s_add_u32 s57, s61, 319488
    buffer_load_dwordx4 v20, s[8:11], s57 offen offset:0 sc1 lds
    buffer_load_dwordx4 v20, s[8:11], s57 offen offset:1024 sc1 lds
    buffer_load_dwordx4 v20, s[8:11], s57 offen offset:2048 sc1 lds
    s_waitcnt vmcnt(12)
    s_barrier
    s_add_u32 m0, s65, 49152
    s_add_u32 s57, s61, 344064
    buffer_load_dwordx4 v20, s[8:11], s57 offen offset:0 sc1 lds
    buffer_load_dwordx4 v20, s[8:11], s57 offen offset:1024 sc1 lds
    buffer_load_dwordx4 v20, s[8:11], s57 offen offset:2048 sc1 lds
    s_waitcnt vmcnt(9)
    s_barrier
    s_add_u32 m0, s65, 0
    s_add_u32 s57, s61, 368640
    buffer_load_dwordx4 v20, s[8:11], s57 offen offset:0 sc1 lds
    buffer_load_dwordx4 v20, s[8:11], s57 offen offset:1024 sc1 lds
    buffer_load_dwordx4 v20, s[8:11], s57 offen offset:2048 sc1 lds
    s_waitcnt vmcnt(6)
    s_barrier
    s_waitcnt vmcnt(3)
    s_barrier
    s_waitcnt vmcnt(0)
    s_barrier
M_EXIT:
    s_endpgm
.section .rodata,"a"
.p2align 6
.amdhsa_kernel sequential_preLN__ssm_conv_s4d__glu_gated_reglu__prompt_kernel
  .amdhsa_next_free_vgpr 256
  .amdhsa_next_free_sgpr 100
  .amdhsa_accum_offset 256
  .amdhsa_group_segment_fixed_size 0
  .amdhsa_kernarg_size 112
  .amdhsa_user_sgpr_count 2
  .amdhsa_user_sgpr_kernarg_segment_ptr 1
  .amdhsa_system_sgpr_workgroup_id_x 1
.end_amdhsa_kernel
.text
```
